```python
import torch

def _softmax(x, axis=-1):
    return torch.softmax(x, dim=axis)

def _gelu(x):
    return torch.nn.functional.gelu(x, approximate='tanh')

def _silu(x):
    return torch.nn.functional.silu(x)

def _sigmoid(x):
    return torch.sigmoid(x)

def _layernorm(x, axis=-1, eps=1e-05):
    m = x.mean(dim=axis, keepdim=True)
    v = x.var(dim=axis, keepdim=True, unbiased=False)
    return (x - m) / torch.sqrt(v + eps)

def _scatter_add(tgt, idx, src, axis=0):
    return tgt.clone().index_add_(axis, idx, src)

def _segment_sum(src, seg, n):
    out = torch.zeros((n,) + src.shape[1:], dtype=src.dtype)
    return out.index_add_(0, seg, src)

def _pad(x, pw):
    flat = tuple((v for pair in reversed(pw) for v in pair))
    return torch.nn.functional.pad(x, flat)
kernel_name = 'adaLN_cond__softmax_full_mha__dense_activation_relu__prompt'

def setup_inputs():

    _w = lambda a: (lambda t: t.to(torch.bfloat16) if t.is_floating_point() else t)(torch.as_tensor(a))

    def _A_setup():
        B, S, D = (1, 2048, 1024)
        return {'x': _w((lambda *s: torch.randn(*s, dtype=torch.bfloat16) * 0.05)(B, S, D)), 'wqkv': _w((lambda *s: torch.randn(*s, dtype=torch.bfloat16) * 0.05)(D, 3 * D)), 'wo': _w((lambda *s: torch.randn(*s, dtype=torch.bfloat16) * 0.05)(D, D))}
    _A_in = _A_setup()

    def _B_setup():
        B, S, D, Dff = (1, 2048, 1024, 3584)
        return {'x': _w((lambda *s: torch.randn(*s, dtype=torch.bfloat16) * 0.05)(B, S, D)), 'w1': _w((lambda *s: torch.randn(*s, dtype=torch.bfloat16) * 0.05)(D, Dff)), 'w2': _w((lambda *s: torch.randn(*s, dtype=torch.bfloat16) * 0.05)(Dff, D))}
    _B_in = _B_setup()
    return {'A_x': _A_in['x'], 'A_wqkv': _A_in['wqkv'], 'A_wo': _A_in['wo'], 'B_x': _B_in['x'], 'B_w1': _B_in['w1'], 'B_w2': _B_in['w2'], 'c': _w((lambda *s: torch.randn(*s, dtype=torch.bfloat16) * 0.2)(1, 1024) * 8.0), 'w_mod': _w((lambda *s: torch.randn(*s, dtype=torch.bfloat16) * 0.2)(1024, 6 * 1024) * 1024 ** (-0.5) * 8.0)}

def reference(A_x, A_wqkv, A_wo, B_x, B_w1, B_w2, c, w_mod):

    def _A_ref(x, wqkv, wo):
        B, S, D = x.shape
        H = 32
        Dh = D // H
        qkv = (lambda x, *d: x.permute(*d))((x @ wqkv).reshape(B, S, 3, H, Dh), 2, 0, 3, 1, 4)
        q, k, v = (qkv[0], qkv[1], qkv[2])
        scale = Dh ** (-0.5)
        scores = torch.einsum('bhqd,bhkd->bhqk', q, k) * scale
        p = _softmax(scores, axis=-1)
        o = torch.einsum('bhqk,bhkd->bhqd', p, v)
        return (lambda x, *d: x.permute(*d))(o, 0, 2, 1, 3).reshape(B, S, D) @ wo

    def _B_ref(x, w1, w2):
        h = torch.einsum('bsd,df->bsf', x, w1)
        zero = torch.zeros_like(h)
        h = torch.maximum(h, zero)
        return torch.einsum('bsf,fd->bsd', h, w2)
    x = A_x
    mod = (_silu(c) @ w_mod).reshape(c.shape[0], 6, 1, -1)
    sa, ca, ga, sb, cb, gb = (mod[:, 0].clone(), mod[:, 1].clone(), mod[:, 2].clone(), mod[:, 3].clone(), mod[:, 4].clone(), mod[:, 5].clone())
    h = _layernorm(x, axis=-1) * (1 + ca) + sa
    x = x + ga * _A_ref(h, A_wqkv, A_wo)
    h = _layernorm(x, axis=-1) * (1 + cb) + sb
    x = x + gb * _B_ref(h, B_w1, B_w2)
    return x
```

```asm
; @launch grid=(256,1,1) block=(512,1,1) lds=163840
.amdgcn_target "amdgcn-amd-amdhsa--gfx950"
.text
.globl adaLN_cond__softmax_full_mha__dense_activation_relu__prompt_kernel
.p2align 8
.type adaLN_cond__softmax_full_mha__dense_activation_relu__prompt_kernel,@function
adaLN_cond__softmax_full_mha__dense_activation_relu__prompt_kernel:
  s_cmp_ge_u32 s2, 256
  s_cbranch_scc1 L_adaL_end
  s_load_dwordx16 s[64:79], s[0:1], 0
  s_load_dwordx2 s[80:81], s[0:1], 64
  s_load_dwordx2 s[82:83], s[0:1], 80
  s_load_dwordx2 s[4:5], s[0:1], 72
  v_lshrrev_b32 v1, 6, v0
  v_and_b32 v0, 63, v0
  v_readfirstlane_b32 s3, v1
  v_lshlrev_b32 v2, 4, v0
  s_and_b32 s20, s2, 7
  s_lshr_b32 s21, s2, 4
  s_lshl_b32 s21, s21, 3
  s_add_u32 s20, s20, s21
  s_bitcmp1_b32 s2, 3
  s_cbranch_scc1 L_adaL_fln
  s_and_b32 s22, s20, 31
  s_lshr_b32 s23, s20, 5
  s_lshl_b32 s24, s3, 3
  v_lshrrev_b32 v5, 3, v0
  v_add_u32 v5, s24, v5
  v_and_b32 v6, 7, v0
  v_mul_u32_u24 v3, 49152, v5
  v_lshl_add_u32 v3, v6, 4, v3
  v_lshlrev_b32 v4, 3, v5
  s_mul_i32 s29, s23, 3145728
  s_lshl_b32 s30, s22, 7
  s_add_u32 s29, s29, s30
  s_lshl_b32 s28, s23, 9
  s_lshl_b32 s31, s20, 9
  s_add_u32 s31, s31, 393216
  s_cmp_eq_u32 s3, 1
  s_cselect_b32 s31, s31, 0x40000000
  s_cselect_b32 s32, 3, 7
  s_lshl_b32 s33, s20, 3
  s_add_u32 s33, s33, s3
  s_cmp_eq_u32 s33, 2
  s_cselect_b32 s31, 458752, s31
  v_lshlrev_b32 v10, s32, v0
  v_mov_b32 v11, 0
  v_mov_b32 v12, 0
  v_mov_b32 v13, 0
  s_waitcnt lgkmcnt(0)
  s_mov_b32 s8, s82
  s_and_b32 s9, s83, 0xffff
  s_mov_b32 s10, 268435456
  s_mov_b32 s11, 0x20000
  buffer_store_dwordx2 v[12:13], v10, s[8:11], s31 offen sc0 sc1
  s_cmp_lg_u32 s33, 2
  s_cbranch_scc1 L_adaL_gv_noz2
  s_mov_b32 s31, 466944
  buffer_store_dwordx2 v[12:13], v10, s[8:11], s31 offen sc0 sc1
L_adaL_gv_noz2:
  s_mov_b32 s16, s76
  s_and_b32 s17, s77, 0xffff
  s_mov_b32 s18, 2048
  s_mov_b32 s19, 0x20000
  buffer_load_dwordx2 v[8:9], v4, s[16:19], s28 offen
  s_mov_b32 s12, s78
  s_and_b32 s13, s79, 0xffff
  s_mov_b32 s14, 12582912
  s_mov_b32 s15, 0x20000
  buffer_load_dwordx4 v[64:67], v3, s[12:15], s29 offen
  s_add_u32 s29, s29, 12288
  buffer_load_dwordx4 v[68:71], v3, s[12:15], s29 offen
  s_add_u32 s29, s29, 12288
  buffer_load_dwordx4 v[72:75], v3, s[12:15], s29 offen
  s_add_u32 s29, s29, 12288
  buffer_load_dwordx4 v[76:79], v3, s[12:15], s29 offen
  s_mov_b32 s16, s4
  s_and_b32 s17, s5, 0xffff
  s_mov_b32 s18, 256
  s_mov_b32 s19, 0x20000
  s_cmp_lg_u32 s33, 2
  s_cbranch_scc1 L_adaL_gv_nordy
  v_mov_b32 v14, 1
  s_waitcnt vmcnt(5)
  buffer_store_dword v14, v11, s[16:19], 0 offen sc0 sc1
  s_waitcnt vmcnt(5)
L_adaL_gv_nordy:
  s_mov_b32 s29, 0xbfb8aa3b
  v_lshrrev_b32 v7, 1, v5
  v_lshlrev_b32 v7, 8, v7
  v_lshl_add_u32 v7, v6, 5, v7
  s_add_u32 s30, s28, 57344
  s_cmp_eq_u32 s22, 0
  s_cselect_b32 s30, s30, 0x40000000
  s_cmp_eq_u32 s33, 2
  s_cbranch_scc1 L_adaL_gv_havec
  s_waitcnt vmcnt(4)
L_adaL_gv_havec:
  v_lshlrev_b32 v16, 16, v8
  v_and_b32 v17, 0xffff0000, v8
  v_lshlrev_b32 v18, 16, v9
  v_and_b32 v19, 0xffff0000, v9
  v_mul_f32 v20, s29, v16
  v_mul_f32 v21, s29, v17
  v_mul_f32 v22, s29, v18
  v_mul_f32 v23, s29, v19
  v_exp_f32 v20, v20
  v_exp_f32 v21, v21
  v_exp_f32 v22, v22
  v_exp_f32 v23, v23
  v_add_f32 v20, 1.0, v20
  v_add_f32 v21, 1.0, v21
  v_add_f32 v22, 1.0, v22
  v_add_f32 v23, 1.0, v23
  v_rcp_f32 v20, v20
  v_rcp_f32 v21, v21
  v_rcp_f32 v22, v22
  v_rcp_f32 v23, v23
  v_mul_f32 v16, v16, v20
  v_mul_f32 v17, v17, v21
  v_mul_f32 v18, v18, v22
  v_mul_f32 v19, v19, v23
  v_cvt_pk_bf16_f32 v8, v16, v17
  v_cvt_pk_bf16_f32 v9, v18, v19
  buffer_store_dwordx2 v[8:9], v4, s[8:11], s30 offen sc1
  s_cmp_eq_u32 s3, 0
  s_cselect_b32 s35, 0, 0x1000
  buffer_load_dword v15, v11, s[16:19], s35 offen sc0 sc1
  v_lshlrev_b32 v16, 16, v8
  v_and_b32 v17, 0xffff0000, v8
  v_lshlrev_b32 v18, 16, v9
  v_and_b32 v19, 0xffff0000, v9
  s_waitcnt vmcnt(5)
  v_lshlrev_b32 v48, 16, v64
  v_and_b32 v49, 0xffff0000, v64
  v_lshlrev_b32 v50, 16, v65
  v_and_b32 v51, 0xffff0000, v65
  v_lshlrev_b32 v52, 16, v66
  v_and_b32 v53, 0xffff0000, v66
  v_lshlrev_b32 v54, 16, v67
  v_and_b32 v55, 0xffff0000, v67
  v_mul_f32 v24, v48, v16
  v_mul_f32 v25, v49, v16
  v_mul_f32 v26, v50, v16
  v_mul_f32 v27, v51, v16
  v_mul_f32 v28, v52, v16
  v_mul_f32 v29, v53, v16
  v_mul_f32 v30, v54, v16
  v_mul_f32 v31, v55, v16
  s_waitcnt vmcnt(4)
  v_lshlrev_b32 v48, 16, v68
  v_and_b32 v49, 0xffff0000, v68
  v_lshlrev_b32 v50, 16, v69
  v_and_b32 v51, 0xffff0000, v69
  v_lshlrev_b32 v52, 16, v70
  v_and_b32 v53, 0xffff0000, v70
  v_lshlrev_b32 v54, 16, v71
  v_and_b32 v55, 0xffff0000, v71
  v_fmac_f32 v24, v48, v17
  v_fmac_f32 v25, v49, v17
  v_fmac_f32 v26, v50, v17
  v_fmac_f32 v27, v51, v17
  v_fmac_f32 v28, v52, v17
  v_fmac_f32 v29, v53, v17
  v_fmac_f32 v30, v54, v17
  v_fmac_f32 v31, v55, v17
  s_waitcnt vmcnt(3)
  v_lshlrev_b32 v48, 16, v72
  v_and_b32 v49, 0xffff0000, v72
  v_lshlrev_b32 v50, 16, v73
  v_and_b32 v51, 0xffff0000, v73
  v_lshlrev_b32 v52, 16, v74
  v_and_b32 v53, 0xffff0000, v74
  v_lshlrev_b32 v54, 16, v75
  v_and_b32 v55, 0xffff0000, v75
  v_fmac_f32 v24, v48, v18
  v_fmac_f32 v25, v49, v18
  v_fmac_f32 v26, v50, v18
  v_fmac_f32 v27, v51, v18
  v_fmac_f32 v28, v52, v18
  v_fmac_f32 v29, v53, v18
  v_fmac_f32 v30, v54, v18
  v_fmac_f32 v31, v55, v18
  s_waitcnt vmcnt(2)
  v_lshlrev_b32 v48, 16, v76
  v_and_b32 v49, 0xffff0000, v76
  v_lshlrev_b32 v50, 16, v77
  v_and_b32 v51, 0xffff0000, v77
  v_lshlrev_b32 v52, 16, v78
  v_and_b32 v53, 0xffff0000, v78
  v_lshlrev_b32 v54, 16, v79
  v_and_b32 v55, 0xffff0000, v79
  v_fmac_f32 v24, v48, v19
  v_fmac_f32 v25, v49, v19
  v_fmac_f32 v26, v50, v19
  v_fmac_f32 v27, v51, v19
  v_fmac_f32 v28, v52, v19
  v_fmac_f32 v29, v53, v19
  v_fmac_f32 v30, v54, v19
  v_fmac_f32 v31, v55, v19
  s_nop 1
  v_add_f32_dpp v24, v24, v24 row_ror:8 row_mask:0xf bank_mask:0xf
  v_add_f32_dpp v25, v25, v25 row_ror:8 row_mask:0xf bank_mask:0xf
  v_add_f32_dpp v26, v26, v26 row_ror:8 row_mask:0xf bank_mask:0xf
  v_add_f32_dpp v27, v27, v27 row_ror:8 row_mask:0xf bank_mask:0xf
  v_add_f32_dpp v28, v28, v28 row_ror:8 row_mask:0xf bank_mask:0xf
  v_add_f32_dpp v29, v29, v29 row_ror:8 row_mask:0xf bank_mask:0xf
  v_add_f32_dpp v30, v30, v30 row_ror:8 row_mask:0xf bank_mask:0xf
  v_add_f32_dpp v31, v31, v31 row_ror:8 row_mask:0xf bank_mask:0xf
  ds_write_b128 v7, v[24:27]
  ds_write_b128 v7, v[28:31] offset:16
  s_mov_b32 s32, s66
  s_and_b32 s33, s67, 0xffff
  s_mov_b32 s34, 6291456
  s_mov_b32 s35, 0x20000
  s_sub_u32 s40, s3, 1
  s_cmp_ge_u32 s40, 3
  s_cselect_b32 s41, 1, 0
  s_mul_i32 s42, s41, 3
  s_sub_u32 s42, s40, s42
  s_cmp_ge_u32 s40, 6
  s_cselect_b32 s34, 0, s34
  s_lshl_b32 s41, s41, 4
  s_lshr_b32 s43, s20, 3
  s_add_u32 s41, s41, s43
  s_mul_i32 s41, s41, 98304
  s_and_b32 s42, s42, 3
  s_lshl_b32 s42, s42, 11
  s_add_u32 s41, s41, s42
  s_bfe_u32 s42, s2, 0x20001
  s_lshl_b32 s42, s42, 9
  s_add_u32 s41, s41, s42
  v_lshrrev_b32 v20, 2, v0
  v_mul_u32_u24 v20, 6144, v20
  v_and_b32 v21, 3, v0
  v_lshl_add_u32 v20, v21, 7, v20
  s_waitcnt vmcnt(0) lgkmcnt(0)
  s_barrier
  s_cmp_lg_u32 s3, 0
  s_cbranch_scc1 L_adaL_gv_nored
  v_lshlrev_b32 v6, 2, v0
  ds_read_b32 v64, v6 offset:0
  ds_read_b32 v65, v6 offset:256
  ds_read_b32 v66, v6 offset:512
  ds_read_b32 v67, v6 offset:768
  ds_read_b32 v68, v6 offset:1024
  ds_read_b32 v69, v6 offset:1280
  ds_read_b32 v70, v6 offset:1536
  ds_read_b32 v71, v6 offset:1792
  ds_read_b32 v72, v6 offset:2048
  ds_read_b32 v73, v6 offset:2304
  ds_read_b32 v74, v6 offset:2560
  ds_read_b32 v75, v6 offset:2816
  ds_read_b32 v76, v6 offset:3072
  ds_read_b32 v77, v6 offset:3328
  ds_read_b32 v78, v6 offset:3584
  ds_read_b32 v79, v6 offset:3840
  ds_read_b32 v80, v6 offset:4096
  ds_read_b32 v81, v6 offset:4352
  ds_read_b32 v82, v6 offset:4608
  ds_read_b32 v83, v6 offset:4864
  ds_read_b32 v84, v6 offset:5120
  ds_read_b32 v85, v6 offset:5376
  ds_read_b32 v86, v6 offset:5632
  ds_read_b32 v87, v6 offset:5888
  ds_read_b32 v88, v6 offset:6144
  ds_read_b32 v89, v6 offset:6400
  ds_read_b32 v90, v6 offset:6656
  ds_read_b32 v91, v6 offset:6912
  ds_read_b32 v92, v6 offset:7168
  ds_read_b32 v93, v6 offset:7424
  ds_read_b32 v94, v6 offset:7680
  ds_read_b32 v95, v6 offset:7936
  s_lshl_b32 s37, s23, 13
  s_lshl_b32 s38, s22, 8
  s_add_u32 s37, s37, s38
  s_add_u32 s37, s37, 131072
  s_lshl_b32 s40, s23, 7
  s_add_u32 s40, s40, 458752
  v_lshlrev_b32 v58, 9, v0
  v_mov_b32 v59, 1
  s_waitcnt lgkmcnt(15)
  v_add_f32 v64, v64, v72
  v_add_f32 v65, v65, v73
  v_add_f32 v66, v66, v74
  v_add_f32 v67, v67, v75
  v_add_f32 v68, v68, v76
  v_add_f32 v69, v69, v77
  v_add_f32 v70, v70, v78
  v_add_f32 v71, v71, v79
  v_add_f32 v64, v64, v68
  v_add_f32 v65, v65, v69
  v_add_f32 v66, v66, v70
  v_add_f32 v67, v67, v71
  v_add_f32 v64, v64, v66
  v_add_f32 v65, v65, v67
  v_add_f32 v64, v64, v65
  s_waitcnt lgkmcnt(0)
  v_add_f32 v80, v80, v88
  v_add_f32 v81, v81, v89
  v_add_f32 v82, v82, v90
  v_add_f32 v83, v83, v91
  v_add_f32 v84, v84, v92
  v_add_f32 v85, v85, v93
  v_add_f32 v86, v86, v94
  v_add_f32 v87, v87, v95
  v_add_f32 v80, v80, v84
  v_add_f32 v81, v81, v85
  v_add_f32 v82, v82, v86
  v_add_f32 v83, v83, v87
  v_add_f32 v80, v80, v82
  v_add_f32 v81, v81, v83
  v_add_f32 v80, v80, v81
  v_add_f32 v64, v64, v80
  buffer_store_dword v64, v6, s[8:11], s37 offen sc1
  s_mov_b32 s39, s34
  s_mov_b32 s62, 0
L_adaL_gv_rdy:
  v_readfirstlane_b32 s34, v15
  s_add_u32 s62, s62, 1
  s_cmp_gt_u32 s62, 0x80000
  s_cselect_b32 s34, 1, s34
  s_cmp_lg_u32 s34, 0
  s_cbranch_scc1 L_adaL_gv_rdyx
  buffer_load_dword v15, v11, s[16:19], 0 offen sc0 sc1
  s_waitcnt vmcnt(0)
  s_branch L_adaL_gv_rdy
L_adaL_gv_rdyx:
  s_mov_b32 s34, s39
  s_waitcnt vmcnt(0)
  s_mov_b64 exec, 0xffff
  buffer_atomic_add v59, v58, s[8:11], s40 offen sc1
  s_mov_b64 exec, -1
L_adaL_gv_nored:
  s_barrier
  buffer_load_dword v22, v20, s[32:35], s41 offen
  s_add_u32 s41, s41, 3145728
  buffer_load_dword v23, v20, s[32:35], s41 offen
  s_branch L_adaL_fdone
L_adaL_fln:
  v_and_b32 v5, 15, v0
  v_lshrrev_b32 v6, 4, v0
  v_lshlrev_b32 v10, 11, v5
  v_lshl_add_u32 v10, v6, 4, v10
  s_lshl_b32 s30, s20, 15
  s_lshl_b32 s31, s3, 8
  s_add_u32 s30, s30, s31
  v_mov_b32 v11, 0
  s_waitcnt lgkmcnt(0)
  s_mov_b32 s16, s4
  s_and_b32 s17, s5, 0xffff
  s_mov_b32 s18, 256
  s_mov_b32 s19, 0x20000
  s_mov_b32 s12, s64
  s_and_b32 s13, s65, 0xffff
  s_mov_b32 s14, 4194304
  s_mov_b32 s15, 0x20000
  s_mov_b32 s8, s82
  s_and_b32 s9, s83, 0xffff
  s_mov_b32 s10, 268435456
  s_mov_b32 s11, 0x20000
  s_getpc_b64 s[60:61]
L_adaL_ln_pc357:
  s_add_u32 s60, s60, adaLN_cond__softmax_full_mha__dense_activation_relu__prompt_kernel-L_adaL_ln_pc357
  s_addc_u32 s61, s61, -1
  s_lshr_b32 s62, s20, 3
  s_lshl_b32 s62, s62, 12
  v_and_b32 v120, 31, v0
  v_lshlrev_b32 v120, 7, v120
  v_add_u32 v120, s62, v120
  v_min_u32 v120, adaLN_cond__softmax_full_mha__dense_activation_relu__prompt_kernel_end-adaLN_cond__softmax_full_mha__dense_activation_relu__prompt_kernel-4, v120
  v_mov_b32 v121, s61
  v_add_co_u32 v120, vcc, s60, v120
  s_nop 1
  v_addc_co_u32 v121, vcc, 0, v121, vcc
  global_load_dword v122, v[120:121], off
  s_cmp_eq_u32 s3, 0
  s_cselect_b32 s35, 0, 0x1000
  s_waitcnt vmcnt(0)
  buffer_load_dwordx4 v[128:131], v10, s[12:15], s30 offen offset:0
  buffer_load_dwordx4 v[132:135], v10, s[12:15], s30 offen offset:64
  buffer_load_dwordx4 v[136:139], v10, s[12:15], s30 offen offset:128
  buffer_load_dwordx4 v[140:143], v10, s[12:15], s30 offen offset:192
  buffer_load_dword v15, v11, s[16:19], s35 offen sc0 sc1
  v_lshrrev_b32 v7, 5, v0
  v_cvt_f32_u32 v14, v7
  v_and_b32 v8, 31, v0
  v_lshlrev_b32 v7, 12, v7
  v_lshl_add_u32 v7, v8, 4, v7
  s_lshl_b32 s26, s3, 9
  s_add_u32 s26, s26, 131072
  s_lshl_b32 s25, s3, 10
  v_add_u32 v9, s25, v2
  v_lshlrev_b32 v12, 5, v6
  v_add_u32 v12, s25, v12
  s_lshl_b32 s27, s3, 2
  v_lshlrev_b32 v13, 5, v5
  v_add_u32 v16, s27, v13
  v_lshlrev_b32 v18, 9, v6
  v_lshl_add_u32 v18, v5, 4, v18
  s_lshr_b32 s29, s20, 1
  s_mul_i32 s29, s29, 66560
  s_and_b32 s32, s20, 1
  s_lshl_b32 s32, s32, 8
  s_add_u32 s29, s29, s32
  s_lshl_b32 s32, s3, 13
  s_add_u32 s29, s29, s32
  s_add_u32 s29, s29, 1048576
  s_add_u32 s33, s29, 4096
  s_and_b32 s40, s20, 15
  s_lshl_b32 s40, s40, 9
  s_add_u32 s40, s40, 458752
  v_lshlrev_b32 v56, 7, v0
  v_mov_b32 v57, 0
  s_waitcnt vmcnt(0)
  s_cmp_lg_u32 s3, 0
  s_cbranch_scc1 L_adaL_ln_nosmp
  s_mov_b32 s62, 0
L_adaL_ln_rdy:
  v_readfirstlane_b32 s34, v15
  s_add_u32 s62, s62, 1
  s_cmp_gt_u32 s62, 0x80000
  s_cselect_b32 s34, 1, s34
  s_cmp_lg_u32 s34, 0
  s_cbranch_scc1 L_adaL_ln_rdyx
  buffer_load_dword v15, v11, s[16:19], 0 offen sc0 sc1
  s_waitcnt vmcnt(0)
  s_branch L_adaL_ln_rdy
L_adaL_ln_rdyx:
  s_mov_b64 exec, 15
  buffer_atomic_add v57, v56, s[8:11], s40 offen sc0 sc1
  s_mov_b64 exec, -1
L_adaL_ln_nosmp:
  v_lshlrev_b32 v144, 16, v128
  v_and_b32 v145, 0xffff0000, v128
  v_lshlrev_b32 v146, 16, v129
  v_and_b32 v147, 0xffff0000, v129
  v_lshlrev_b32 v148, 16, v130
  v_and_b32 v149, 0xffff0000, v130
  v_lshlrev_b32 v150, 16, v131
  v_and_b32 v151, 0xffff0000, v131
  v_lshlrev_b32 v152, 16, v132
  v_and_b32 v153, 0xffff0000, v132
  v_lshlrev_b32 v154, 16, v133
  v_and_b32 v155, 0xffff0000, v133
  v_lshlrev_b32 v156, 16, v134
  v_and_b32 v157, 0xffff0000, v134
  v_lshlrev_b32 v158, 16, v135
  v_and_b32 v159, 0xffff0000, v135
  v_lshlrev_b32 v160, 16, v136
  v_and_b32 v161, 0xffff0000, v136
  v_lshlrev_b32 v162, 16, v137
  v_and_b32 v163, 0xffff0000, v137
  v_lshlrev_b32 v164, 16, v138
  v_and_b32 v165, 0xffff0000, v138
  v_lshlrev_b32 v166, 16, v139
  v_and_b32 v167, 0xffff0000, v139
  v_lshlrev_b32 v168, 16, v140
  v_and_b32 v169, 0xffff0000, v140
  v_lshlrev_b32 v170, 16, v141
  v_and_b32 v171, 0xffff0000, v141
  v_lshlrev_b32 v172, 16, v142
  v_and_b32 v173, 0xffff0000, v142
  v_lshlrev_b32 v174, 16, v143
  v_and_b32 v175, 0xffff0000, v143
  v_add_f32 v176, v144, v145
  v_add_f32 v177, v146, v147
  v_add_f32 v178, v148, v149
  v_add_f32 v179, v150, v151
  v_add_f32 v180, v152, v153
  v_add_f32 v181, v154, v155
  v_add_f32 v182, v156, v157
  v_add_f32 v183, v158, v159
  v_add_f32 v184, v160, v161
  v_add_f32 v185, v162, v163
  v_add_f32 v186, v164, v165
  v_add_f32 v187, v166, v167
  v_add_f32 v188, v168, v169
  v_add_f32 v189, v170, v171
  v_add_f32 v190, v172, v173
  v_add_f32 v191, v174, v175
  v_add_f32 v176, v176, v184
  v_add_f32 v177, v177, v185
  v_add_f32 v178, v178, v186
  v_add_f32 v179, v179, v187
  v_add_f32 v180, v180, v188
  v_add_f32 v181, v181, v189
  v_add_f32 v182, v182, v190
  v_add_f32 v183, v183, v191
  v_add_f32 v176, v176, v180
  v_add_f32 v177, v177, v181
  v_add_f32 v178, v178, v182
  v_add_f32 v179, v179, v183
  v_add_f32 v176, v176, v178
  v_add_f32 v177, v177, v179
  v_add_f32 v176, v176, v177
  v_mov_b32 v177, v176
  s_nop 1
  v_permlane16_swap_b32 v177, v176
  v_add_f32 v176, v176, v177
  v_mov_b32 v177, v176
  s_nop 1
  v_permlane32_swap_b32 v177, v176
  v_add_f32 v176, v176, v177
  ds_write_b32 v16, v176 offset:8192
  s_waitcnt lgkmcnt(0)
  s_barrier
  ds_read_b128 v[176:179], v13 offset:8192
  ds_read_b128 v[180:183], v13 offset:8208
  s_waitcnt lgkmcnt(0)
  v_add_f32 v176, v176, v180
  v_add_f32 v177, v177, v181
  v_add_f32 v178, v178, v182
  v_add_f32 v179, v179, v183
  v_add_f32 v176, v176, v178
  v_add_f32 v177, v177, v179
  v_add_f32 v176, v176, v177
  v_mul_f32 v184, 0x3a800000, v176
  v_sub_f32 v144, v144, v184
  v_sub_f32 v145, v145, v184
  v_sub_f32 v146, v146, v184
  v_sub_f32 v147, v147, v184
  v_sub_f32 v148, v148, v184
  v_sub_f32 v149, v149, v184
  v_sub_f32 v150, v150, v184
  v_sub_f32 v151, v151, v184
  v_sub_f32 v152, v152, v184
  v_sub_f32 v153, v153, v184
  v_sub_f32 v154, v154, v184
  v_sub_f32 v155, v155, v184
  v_sub_f32 v156, v156, v184
  v_sub_f32 v157, v157, v184
  v_sub_f32 v158, v158, v184
  v_sub_f32 v159, v159, v184
  v_sub_f32 v160, v160, v184
  v_sub_f32 v161, v161, v184
  v_sub_f32 v162, v162, v184
  v_sub_f32 v163, v163, v184
  v_sub_f32 v164, v164, v184
  v_sub_f32 v165, v165, v184
  v_sub_f32 v166, v166, v184
  v_sub_f32 v167, v167, v184
  v_sub_f32 v168, v168, v184
  v_sub_f32 v169, v169, v184
  v_sub_f32 v170, v170, v184
  v_sub_f32 v171, v171, v184
  v_sub_f32 v172, v172, v184
  v_sub_f32 v173, v173, v184
  v_sub_f32 v174, v174, v184
  v_sub_f32 v175, v175, v184
  v_mul_f32 v176, v144, v144
  v_mul_f32 v177, v145, v145
  v_mul_f32 v178, v146, v146
  v_mul_f32 v179, v147, v147
  v_fmac_f32 v176, v148, v148
  v_fmac_f32 v177, v149, v149
  v_fmac_f32 v178, v150, v150
  v_fmac_f32 v179, v151, v151
  v_fmac_f32 v176, v152, v152
  v_fmac_f32 v177, v153, v153
  v_fmac_f32 v178, v154, v154
  v_fmac_f32 v179, v155, v155
  v_fmac_f32 v176, v156, v156
  v_fmac_f32 v177, v157, v157
  v_fmac_f32 v178, v158, v158
  v_fmac_f32 v179, v159, v159
  v_fmac_f32 v176, v160, v160
  v_fmac_f32 v177, v161, v161
  v_fmac_f32 v178, v162, v162
  v_fmac_f32 v179, v163, v163
  v_fmac_f32 v176, v164, v164
  v_fmac_f32 v177, v165, v165
  v_fmac_f32 v178, v166, v166
  v_fmac_f32 v179, v167, v167
  v_fmac_f32 v176, v168, v168
  v_fmac_f32 v177, v169, v169
  v_fmac_f32 v178, v170, v170
  v_fmac_f32 v179, v171, v171
  v_fmac_f32 v176, v172, v172
  v_fmac_f32 v177, v173, v173
  v_fmac_f32 v178, v174, v174
  v_fmac_f32 v179, v175, v175
  v_add_f32 v176, v176, v177
  v_add_f32 v178, v178, v179
  v_add_f32 v176, v176, v178
  v_mov_b32 v177, v176
  s_nop 1
  v_permlane16_swap_b32 v177, v176
  v_add_f32 v176, v176, v177
  v_mov_b32 v177, v176
  s_nop 1
  v_permlane32_swap_b32 v177, v176
  v_add_f32 v176, v176, v177
  ds_write_b32 v16, v176 offset:8704
  s_waitcnt lgkmcnt(0)
  s_cmp_lg_u32 s3, 0
  s_cbranch_scc1 L_adaL_ln_b1
  s_waitcnt vmcnt(0)
  s_mov_b64 exec, 15
  v_cmp_gt_u32 vcc, 32, v57
  s_mov_b64 exec, -1
  s_nop 3
  s_cbranch_vccz L_adaL_ln_b1
  v_lshlrev_b32 v56, 7, v0
  s_mov_b32 s62, 0
  s_mov_b64 exec, 15
L_adaL_ln_pg:
  v_mov_b32 v57, 0
  buffer_atomic_add v57, v56, s[8:11], s40 offen sc0 sc1
  s_add_u32 s62, s62, 1
  s_cmp_gt_u32 s62, 0x80000
  s_cbranch_scc1 L_adaL_ln_pgx
  s_waitcnt vmcnt(0)
  v_cmp_gt_u32 vcc, 32, v57
  s_nop 3
  s_cbranch_vccz L_adaL_ln_pgx
  s_sleep 2
  s_branch L_adaL_ln_pg
L_adaL_ln_pgx:
  s_mov_b64 exec, -1
L_adaL_ln_b1:
  s_barrier
  buffer_load_dwordx4 v[32:35], v7, s[8:11], s26 offen sc1
  s_add_u32 s26, s26, 8192
  buffer_load_dwordx4 v[36:39], v7, s[8:11], s26 offen sc1
  s_add_u32 s26, s26, 8192
  buffer_load_dwordx4 v[40:43], v7, s[8:11], s26 offen sc1
  s_add_u32 s26, s26, 8192
  buffer_load_dwordx4 v[44:47], v7, s[8:11], s26 offen sc1
  ds_read_b128 v[176:179], v13 offset:8704
  ds_read_b128 v[180:183], v13 offset:8720
  s_waitcnt lgkmcnt(0)
  v_add_f32 v176, v176, v180
  v_add_f32 v177, v177, v181
  v_add_f32 v178, v178, v182
  v_add_f32 v179, v179, v183
  v_add_f32 v176, v176, v178
  v_add_f32 v177, v177, v179
  v_add_f32 v176, v176, v177
  v_mov_b32 v185, 0x3727c5ac
  v_fmac_f32 v185, 0x3a800000, v176
  v_rsq_f32 v185, v185
  s_lshr_b32 s40, s20, 3
  s_lshl_b32 s40, s40, 7
  s_add_u32 s40, s40, 466944
  v_mul_f32 v144, v144, v185
  v_mul_f32 v145, v145, v185
  v_mul_f32 v146, v146, v185
  v_mul_f32 v147, v147, v185
  v_mul_f32 v148, v148, v185
  v_mul_f32 v149, v149, v185
  v_mul_f32 v150, v150, v185
  v_mul_f32 v151, v151, v185
  v_mul_f32 v152, v152, v185
  v_mul_f32 v153, v153, v185
  v_mul_f32 v154, v154, v185
  v_mul_f32 v155, v155, v185
  v_mul_f32 v156, v156, v185
  v_mul_f32 v157, v157, v185
  v_mul_f32 v158, v158, v185
  v_mul_f32 v159, v159, v185
  v_mul_f32 v160, v160, v185
  v_mul_f32 v161, v161, v185
  v_mul_f32 v162, v162, v185
  v_mul_f32 v163, v163, v185
  v_mul_f32 v164, v164, v185
  v_mul_f32 v165, v165, v185
  v_mul_f32 v166, v166, v185
  v_mul_f32 v167, v167, v185
  v_mul_f32 v168, v168, v185
  v_mul_f32 v169, v169, v185
  v_mul_f32 v170, v170, v185
  v_mul_f32 v171, v171, v185
  v_mul_f32 v172, v172, v185
  v_mul_f32 v173, v173, v185
  v_mul_f32 v174, v174, v185
  v_mul_f32 v175, v175, v185
  s_waitcnt vmcnt(0)
  v_add_f32 v32, v32, v36
  v_add_f32 v40, v40, v44
  v_add_f32 v33, v33, v37
  v_add_f32 v41, v41, v45
  v_add_f32 v34, v34, v38
  v_add_f32 v42, v42, v46
  v_add_f32 v35, v35, v39
  v_add_f32 v43, v43, v47
  v_add_f32 v32, v32, v40
  v_add_f32 v33, v33, v41
  v_add_f32 v34, v34, v42
  v_add_f32 v35, v35, v43
  v_cvt_pk_bf16_f32 v36, v32, v33
  v_cvt_pk_bf16_f32 v37, v34, v35
  v_lshlrev_b32 v32, 16, v36
  v_and_b32 v33, 0xffff0000, v36
  v_lshlrev_b32 v34, 16, v37
  v_and_b32 v35, 0xffff0000, v37
  v_add_f32 v32, v14, v32
  v_add_f32 v33, v14, v33
  v_add_f32 v34, v14, v34
  v_add_f32 v35, v14, v35
  v_cvt_pk_bf16_f32 v36, v32, v33
  v_cvt_pk_bf16_f32 v37, v34, v35
  v_lshlrev_b32 v32, 16, v36
  v_and_b32 v33, 0xffff0000, v36
  v_lshlrev_b32 v34, 16, v37
  v_and_b32 v35, 0xffff0000, v37
  ds_write_b128 v9, v[32:35]
  s_waitcnt lgkmcnt(0)
  ds_read_b128 v[48:51], v12 offset:0
  ds_read_b128 v[80:83], v12 offset:512
  ds_read_b128 v[52:55], v12 offset:16
  ds_read_b128 v[84:87], v12 offset:528
  ds_read_b128 v[56:59], v12 offset:128
  ds_read_b128 v[88:91], v12 offset:640
  ds_read_b128 v[60:63], v12 offset:144
  ds_read_b128 v[92:95], v12 offset:656
  ds_read_b128 v[64:67], v12 offset:256
  ds_read_b128 v[96:99], v12 offset:768
  ds_read_b128 v[68:71], v12 offset:272
  ds_read_b128 v[100:103], v12 offset:784
  ds_read_b128 v[72:75], v12 offset:384
  ds_read_b128 v[104:107], v12 offset:896
  ds_read_b128 v[76:79], v12 offset:400
  ds_read_b128 v[108:111], v12 offset:912
  s_waitcnt lgkmcnt(12)
  v_fmac_f32 v48, v144, v80
  v_fmac_f32 v49, v145, v81
  v_fmac_f32 v50, v146, v82
  v_fmac_f32 v51, v147, v83
  v_fmac_f32 v52, v148, v84
  v_fmac_f32 v53, v149, v85
  v_fmac_f32 v54, v150, v86
  v_fmac_f32 v55, v151, v87
  v_cvt_pk_bf16_f32 v32, v48, v49
  v_cvt_pk_bf16_f32 v33, v50, v51
  v_cvt_pk_bf16_f32 v34, v52, v53
  v_cvt_pk_bf16_f32 v35, v54, v55
  buffer_store_dwordx4 v[32:35], v18, s[8:11], s29 offen offset:0 sc1
  s_waitcnt lgkmcnt(8)
  v_fmac_f32 v56, v152, v88
  v_fmac_f32 v57, v153, v89
  v_fmac_f32 v58, v154, v90
  v_fmac_f32 v59, v155, v91
  v_fmac_f32 v60, v156, v92
  v_fmac_f32 v61, v157, v93
  v_fmac_f32 v62, v158, v94
  v_fmac_f32 v63, v159, v95
  v_cvt_pk_bf16_f32 v36, v56, v57
  v_cvt_pk_bf16_f32 v37, v58, v59
  v_cvt_pk_bf16_f32 v38, v60, v61
  v_cvt_pk_bf16_f32 v39, v62, v63
  buffer_store_dwordx4 v[36:39], v18, s[8:11], s29 offen offset:2048 sc1
  s_waitcnt lgkmcnt(4)
  v_fmac_f32 v64, v160, v96
  v_fmac_f32 v65, v161, v97
  v_fmac_f32 v66, v162, v98
  v_fmac_f32 v67, v163, v99
  v_fmac_f32 v68, v164, v100
  v_fmac_f32 v69, v165, v101
  v_fmac_f32 v70, v166, v102
  v_fmac_f32 v71, v167, v103
  v_cvt_pk_bf16_f32 v40, v64, v65
  v_cvt_pk_bf16_f32 v41, v66, v67
  v_cvt_pk_bf16_f32 v42, v68, v69
  v_cvt_pk_bf16_f32 v43, v70, v71
  buffer_store_dwordx4 v[40:43], v18, s[8:11], s33 offen offset:0 sc1
  s_waitcnt lgkmcnt(0)
  v_fmac_f32 v72, v168, v104
  v_fmac_f32 v73, v169, v105
  v_fmac_f32 v74, v170, v106
  v_fmac_f32 v75, v171, v107
  v_fmac_f32 v76, v172, v108
  v_fmac_f32 v77, v173, v109
  v_fmac_f32 v78, v174, v110
  v_fmac_f32 v79, v175, v111
  v_cvt_pk_bf16_f32 v44, v72, v73
  v_cvt_pk_bf16_f32 v45, v74, v75
  v_cvt_pk_bf16_f32 v46, v76, v77
  v_cvt_pk_bf16_f32 v47, v78, v79
  buffer_store_dwordx4 v[44:47], v18, s[8:11], s33 offen offset:2048 sc1
  s_barrier
  v_mov_b32 v10, 0
  v_mov_b32 v11, 1
  s_mov_b64 exec, 1
  s_waitcnt vmcnt(0)
  buffer_atomic_add v11, v10, s[8:11], s40 offen sc1
  s_mov_b64 exec, -1
L_adaL_fdone:
  s_cmp_lt_u32 s3, 4
  s_cbranch_scc1 L_adaL_roleL
  s_and_b32 s16, s2, 7
  s_lshr_b32 s17, s2, 3
  s_and_b32 s18, s16, 1
  s_lshl_b32 s18, s18, 3
  s_and_b32 s19, s17, 7
  s_add_u32 s18, s18, s19
  s_lshr_b32 s19, s16, 1
  s_lshl_b32 s19, s19, 2
  s_lshr_b32 s17, s17, 3
  s_add_u32 s19, s19, s17
  s_bfe_u32 s20, s3, 0x10001
  s_and_b32 s21, s3, 1
  v_lshrrev_b32 v3, 4, v0
  v_and_b32 v4, 15, v0
  v_lshlrev_b32 v5, 9, v3
  v_lshl_add_u32 v5, v4, 4, v5
  s_mul_i32 s22, s20, 4096
  v_add_u32 v6, s22, v5
  v_bfe_u32 v10, v0, 2, 2
  v_lshlrev_b32 v11, 10, v3
  v_lshl_add_u32 v11, v10, 7, v11
  v_and_b32 v12, 3, v0
  v_lshl_add_u32 v11, v12, 3, v11
  v_lshrrev_b32 v10, 1, v10
  v_and_b32 v12, 1, v3
  v_lshl_or_b32 v10, v12, 1, v10
  s_lshl_b32 s23, s21, 1
  v_xor_b32 v10, s23, v10
  v_lshl_add_u32 v8, v10, 5, v11
  v_xor_b32 v9, 32, v8
  v_mov_b32 v160, 0
  v_mov_b32 v161, 0
  v_mov_b32 v162, 0
  v_mov_b32 v163, 0
  v_mov_b32 v164, 0
  v_mov_b32 v165, 0
  v_mov_b32 v166, 0
  v_mov_b32 v167, 0
  v_mov_b32 v168, 0
  v_mov_b32 v169, 0
  v_mov_b32 v170, 0
  v_mov_b32 v171, 0
  v_mov_b32 v172, 0
  v_mov_b32 v173, 0
  v_mov_b32 v174, 0
  v_mov_b32 v175, 0
  v_mov_b32 v176, 0
  v_mov_b32 v177, 0
  v_mov_b32 v178, 0
  v_mov_b32 v179, 0
  v_mov_b32 v180, 0
  v_mov_b32 v181, 0
  v_mov_b32 v182, 0
  v_mov_b32 v183, 0
  v_mov_b32 v184, 0
  v_mov_b32 v185, 0
  v_mov_b32 v186, 0
  v_mov_b32 v187, 0
  v_mov_b32 v188, 0
  v_mov_b32 v189, 0
  v_mov_b32 v190, 0
  v_mov_b32 v191, 0
  v_mov_b32 v192, 0
  v_mov_b32 v193, 0
  v_mov_b32 v194, 0
  v_mov_b32 v195, 0
  v_mov_b32 v196, 0
  v_mov_b32 v197, 0
  v_mov_b32 v198, 0
  v_mov_b32 v199, 0
  v_mov_b32 v200, 0
  v_mov_b32 v201, 0
  v_mov_b32 v202, 0
  v_mov_b32 v203, 0
  v_mov_b32 v204, 0
  v_mov_b32 v205, 0
  v_mov_b32 v206, 0
  v_mov_b32 v207, 0
  v_mov_b32 v208, 0
  v_mov_b32 v209, 0
  v_mov_b32 v210, 0
  v_mov_b32 v211, 0
  v_mov_b32 v212, 0
  v_mov_b32 v213, 0
  v_mov_b32 v214, 0
  v_mov_b32 v215, 0
  v_mov_b32 v216, 0
  v_mov_b32 v217, 0
  v_mov_b32 v218, 0
  v_mov_b32 v219, 0
  v_mov_b32 v220, 0
  v_mov_b32 v221, 0
  v_mov_b32 v222, 0
  v_mov_b32 v223, 0
  v_mov_b32 v224, 0
  v_mov_b32 v225, 0
  v_mov_b32 v226, 0
  v_mov_b32 v227, 0
  v_mov_b32 v228, 0
  v_mov_b32 v229, 0
  v_mov_b32 v230, 0
  v_mov_b32 v231, 0
  v_mov_b32 v232, 0
  v_mov_b32 v233, 0
  v_mov_b32 v234, 0
  v_mov_b32 v235, 0
  v_mov_b32 v236, 0
  v_mov_b32 v237, 0
  v_mov_b32 v238, 0
  v_mov_b32 v239, 0
  v_mov_b32 v240, 0
  v_mov_b32 v241, 0
  v_mov_b32 v242, 0
  v_mov_b32 v243, 0
  v_mov_b32 v244, 0
  v_mov_b32 v245, 0
  v_mov_b32 v246, 0
  v_mov_b32 v247, 0
  v_mov_b32 v248, 0
  v_mov_b32 v249, 0
  v_mov_b32 v250, 0
  v_mov_b32 v251, 0
  v_mov_b32 v252, 0
  v_mov_b32 v253, 0
  v_mov_b32 v254, 0
  v_mov_b32 v255, 0
  s_lshl_b32 s26, s18, 2
  s_lshl_b32 s27, s20, 1
  s_add_u32 s26, s26, s27
  s_mov_b32 s23, 0
  s_mov_b32 s24, 0
  v_add_u32 v14, s23, v6
  v_add_u32 v16, s23, v8
  v_add_u32 v17, s23, v9
  s_barrier
  s_barrier
  ds_read_b128 v[80:83], v14 offset:0
  ds_read_b128 v[84:87], v14 offset:256
  ds_read_b128 v[88:91], v14 offset:2048
  ds_read_b128 v[92:95], v14 offset:2304
  ds_read_b64_tr_b16 v[96:97], v16 offset:8192
  ds_read_b64_tr_b16 v[98:99], v16 offset:8704
  ds_read_b64_tr_b16 v[100:101], v17 offset:8192
  ds_read_b64_tr_b16 v[102:103], v17 offset:8704
  ds_read_b64_tr_b16 v[104:105], v16 offset:12288
  ds_read_b64_tr_b16 v[106:107], v16 offset:12800
  ds_read_b64_tr_b16 v[108:109], v17 offset:12288
  ds_read_b64_tr_b16 v[110:111], v17 offset:12800
  ds_read_b64_tr_b16 v[112:113], v16 offset:16384
  ds_read_b64_tr_b16 v[114:115], v16 offset:16896
  ds_read_b64_tr_b16 v[116:117], v17 offset:16384
  ds_read_b64_tr_b16 v[118:119], v17 offset:16896
  s_add_u32 s23, s23, 20480
  s_cmp_eq_u32 s23, 163840
  s_cselect_b32 s23, 0, s23
  v_add_u32 v14, s23, v6
  v_add_u32 v16, s23, v8
  v_add_u32 v17, s23, v9
  s_branch L_adaL_qkvC_cmid
L_adaL_qkvC_cloop:
  s_barrier
  v_mfma_f32_16x16x32_bf16 v[160:163], v[136:139], v[120:123], v[160:163]
  ds_read_b128 v[80:83], v14 offset:0
  v_mfma_f32_16x16x32_bf16 v[184:187], v[136:139], v[124:127], v[184:187]
  ds_read_b128 v[84:87], v14 offset:256
  v_mfma_f32_16x16x32_bf16 v[208:211], v[136:139], v[128:131], v[208:211]
  ds_read_b128 v[88:91], v14 offset:2048
  v_mfma_f32_16x16x32_bf16 v[232:235], v[136:139], v[132:135], v[232:235]
  ds_read_b128 v[92:95], v14 offset:2304
  v_mfma_f32_16x16x32_bf16 v[164:167], v[140:143], v[120:123], v[164:167]
  ds_read_b64_tr_b16 v[96:97], v16 offset:8192
  v_mfma_f32_16x16x32_bf16 v[188:191], v[140:143], v[124:127], v[188:191]
  ds_read_b64_tr_b16 v[98:99], v16 offset:8704
  v_mfma_f32_16x16x32_bf16 v[212:215], v[140:143], v[128:131], v[212:215]
  ds_read_b64_tr_b16 v[100:101], v17 offset:8192
  v_mfma_f32_16x16x32_bf16 v[236:239], v[140:143], v[132:135], v[236:239]
  ds_read_b64_tr_b16 v[102:103], v17 offset:8704
  v_mfma_f32_16x16x32_bf16 v[168:171], v[144:147], v[120:123], v[168:171]
  ds_read_b64_tr_b16 v[104:105], v16 offset:12288
  v_mfma_f32_16x16x32_bf16 v[192:195], v[144:147], v[124:127], v[192:195]
  ds_read_b64_tr_b16 v[106:107], v16 offset:12800
  v_mfma_f32_16x16x32_bf16 v[216:219], v[144:147], v[128:131], v[216:219]
  ds_read_b64_tr_b16 v[108:109], v17 offset:12288
  v_mfma_f32_16x16x32_bf16 v[240:243], v[144:147], v[132:135], v[240:243]
  ds_read_b64_tr_b16 v[110:111], v17 offset:12800
  v_mfma_f32_16x16x32_bf16 v[172:175], v[148:151], v[120:123], v[172:175]
  ds_read_b64_tr_b16 v[112:113], v16 offset:16384
  v_mfma_f32_16x16x32_bf16 v[196:199], v[148:151], v[124:127], v[196:199]
  ds_read_b64_tr_b16 v[114:115], v16 offset:16896
  v_mfma_f32_16x16x32_bf16 v[220:223], v[148:151], v[128:131], v[220:223]
  ds_read_b64_tr_b16 v[116:117], v17 offset:16384
  v_mfma_f32_16x16x32_bf16 v[244:247], v[148:151], v[132:135], v[244:247]
  ds_read_b64_tr_b16 v[118:119], v17 offset:16896
  v_mfma_f32_16x16x32_bf16 v[176:179], v[120:123], v[152:155], v[176:179]
  s_add_u32 s23, s23, 20480
  v_mfma_f32_16x16x32_bf16 v[200:203], v[124:127], v[152:155], v[200:203]
  s_cmp_eq_u32 s23, 163840
  v_mfma_f32_16x16x32_bf16 v[224:227], v[128:131], v[152:155], v[224:227]
  s_cselect_b32 s23, 0, s23
  v_mfma_f32_16x16x32_bf16 v[248:251], v[132:135], v[152:155], v[248:251]
  v_add_u32 v14, s23, v6
  v_mfma_f32_16x16x32_bf16 v[180:183], v[120:123], v[156:159], v[180:183]
  v_add_u32 v16, s23, v8
  v_mfma_f32_16x16x32_bf16 v[204:207], v[124:127], v[156:159], v[204:207]
  v_add_u32 v17, s23, v9
  v_mfma_f32_16x16x32_bf16 v[228:231], v[128:131], v[156:159], v[228:231]
  v_mfma_f32_16x16x32_bf16 v[252:255], v[132:135], v[156:159], v[252:255]
L_adaL_qkvC_cmid:
  s_waitcnt lgkmcnt(0)
  s_barrier
  v_mfma_f32_16x16x32_bf16 v[160:163], v[96:99], v[80:83], v[160:163]
  ds_read_b128 v[120:123], v14 offset:0
  ds_read_b128 v[124:127], v14 offset:256
  v_mfma_f32_16x16x32_bf16 v[184:187], v[96:99], v[84:87], v[184:187]
  ds_read_b128 v[128:131], v14 offset:2048
  ds_read_b128 v[132:135], v14 offset:2304
  v_mfma_f32_16x16x32_bf16 v[208:211], v[96:99], v[88:91], v[208:211]
  ds_read_b64_tr_b16 v[136:137], v16 offset:8192
  ds_read_b64_tr_b16 v[138:139], v16 offset:8704
  v_mfma_f32_16x16x32_bf16 v[232:235], v[96:99], v[92:95], v[232:235]
  ds_read_b64_tr_b16 v[140:141], v17 offset:8192
  ds_read_b64_tr_b16 v[142:143], v17 offset:8704
  v_mfma_f32_16x16x32_bf16 v[164:167], v[100:103], v[80:83], v[164:167]
  ds_read_b64_tr_b16 v[144:145], v16 offset:12288
  ds_read_b64_tr_b16 v[146:147], v16 offset:12800
  v_mfma_f32_16x16x32_bf16 v[188:191], v[100:103], v[84:87], v[188:191]
  ds_read_b64_tr_b16 v[148:149], v17 offset:12288
  ds_read_b64_tr_b16 v[150:151], v17 offset:12800
  v_mfma_f32_16x16x32_bf16 v[212:215], v[100:103], v[88:91], v[212:215]
  ds_read_b64_tr_b16 v[152:153], v16 offset:16384
  ds_read_b64_tr_b16 v[154:155], v16 offset:16896
  v_mfma_f32_16x16x32_bf16 v[236:239], v[100:103], v[92:95], v[236:239]
  ds_read_b64_tr_b16 v[156:157], v17 offset:16384
  ds_read_b64_tr_b16 v[158:159], v17 offset:16896
  v_mfma_f32_16x16x32_bf16 v[168:171], v[104:107], v[80:83], v[168:171]
  s_add_u32 s23, s23, 20480
  s_cmp_eq_u32 s23, 163840
  v_mfma_f32_16x16x32_bf16 v[192:195], v[104:107], v[84:87], v[192:195]
  s_cselect_b32 s23, 0, s23
  v_add_u32 v14, s23, v6
  v_mfma_f32_16x16x32_bf16 v[216:219], v[104:107], v[88:91], v[216:219]
  v_add_u32 v16, s23, v8
  v_add_u32 v17, s23, v9
  v_mfma_f32_16x16x32_bf16 v[240:243], v[104:107], v[92:95], v[240:243]
  s_add_u32 s24, s24, 1
  v_mfma_f32_16x16x32_bf16 v[172:175], v[108:111], v[80:83], v[172:175]
  v_mfma_f32_16x16x32_bf16 v[196:199], v[108:111], v[84:87], v[196:199]
  v_mfma_f32_16x16x32_bf16 v[220:223], v[108:111], v[88:91], v[220:223]
  v_mfma_f32_16x16x32_bf16 v[244:247], v[108:111], v[92:95], v[244:247]
  v_mfma_f32_16x16x32_bf16 v[176:179], v[80:83], v[112:115], v[176:179]
  v_mfma_f32_16x16x32_bf16 v[200:203], v[84:87], v[112:115], v[200:203]
  v_mfma_f32_16x16x32_bf16 v[224:227], v[88:91], v[112:115], v[224:227]
  v_mfma_f32_16x16x32_bf16 v[248:251], v[92:95], v[112:115], v[248:251]
  v_mfma_f32_16x16x32_bf16 v[180:183], v[80:83], v[116:119], v[180:183]
  v_mfma_f32_16x16x32_bf16 v[204:207], v[84:87], v[116:119], v[204:207]
  v_mfma_f32_16x16x32_bf16 v[228:231], v[88:91], v[116:119], v[228:231]
  v_mfma_f32_16x16x32_bf16 v[252:255], v[92:95], v[116:119], v[252:255]
  s_cmp_lt_u32 s24, 16
  s_waitcnt lgkmcnt(0)
  s_cbranch_scc1 L_adaL_qkvC_cloop
  s_barrier
  v_mfma_f32_16x16x32_bf16 v[160:163], v[136:139], v[120:123], v[160:163]
  v_mfma_f32_16x16x32_bf16 v[184:187], v[136:139], v[124:127], v[184:187]
  v_mfma_f32_16x16x32_bf16 v[208:211], v[136:139], v[128:131], v[208:211]
  v_mfma_f32_16x16x32_bf16 v[232:235], v[136:139], v[132:135], v[232:235]
  v_mfma_f32_16x16x32_bf16 v[164:167], v[140:143], v[120:123], v[164:167]
  v_mfma_f32_16x16x32_bf16 v[188:191], v[140:143], v[124:127], v[188:191]
  v_mfma_f32_16x16x32_bf16 v[212:215], v[140:143], v[128:131], v[212:215]
  v_mfma_f32_16x16x32_bf16 v[236:239], v[140:143], v[132:135], v[236:239]
  v_mfma_f32_16x16x32_bf16 v[168:171], v[144:147], v[120:123], v[168:171]
  v_mfma_f32_16x16x32_bf16 v[192:195], v[144:147], v[124:127], v[192:195]
  v_mfma_f32_16x16x32_bf16 v[216:219], v[144:147], v[128:131], v[216:219]
  v_mfma_f32_16x16x32_bf16 v[240:243], v[144:147], v[132:135], v[240:243]
  v_mfma_f32_16x16x32_bf16 v[172:175], v[148:151], v[120:123], v[172:175]
  v_mfma_f32_16x16x32_bf16 v[196:199], v[148:151], v[124:127], v[196:199]
  v_mfma_f32_16x16x32_bf16 v[220:223], v[148:151], v[128:131], v[220:223]
  v_mfma_f32_16x16x32_bf16 v[244:247], v[148:151], v[132:135], v[244:247]
  v_mfma_f32_16x16x32_bf16 v[176:179], v[120:123], v[152:155], v[176:179]
  v_mfma_f32_16x16x32_bf16 v[200:203], v[124:127], v[152:155], v[200:203]
  v_mfma_f32_16x16x32_bf16 v[224:227], v[128:131], v[152:155], v[224:227]
  v_mfma_f32_16x16x32_bf16 v[248:251], v[132:135], v[152:155], v[248:251]
  v_mfma_f32_16x16x32_bf16 v[180:183], v[120:123], v[156:159], v[180:183]
  v_mfma_f32_16x16x32_bf16 v[204:207], v[124:127], v[156:159], v[204:207]
  v_mfma_f32_16x16x32_bf16 v[228:231], v[128:131], v[156:159], v[228:231]
  v_mfma_f32_16x16x32_bf16 v[252:255], v[132:135], v[156:159], v[252:255]
  s_lshl_b32 s58, s19, 8
  s_lshr_b32 s42, s18, 3
  s_lshl_b32 s42, s42, 7
  s_add_u32 s58, s58, s42
  s_add_u32 s58, s58, 397312
  s_lshl_b32 s25, s19, 1
  s_add_u32 s25, s25, s21
  s_lshl_b32 s25, s25, 6
  s_add_u32 s25, s25, s26
  s_lshl_b32 s28, s25, 11
  s_add_u32 s28, s28, 5373952
  s_lshl_b32 s29, s25, 12
  s_add_u32 s29, s29, 9568256
  s_add_u32 s30, s29, 4096
  s_mov_b32 s31, 0x3e8293ee
  v_and_b32 v18, 8, v4
  v_lshl_add_u32 v18, v18, 4, v5
  v_and_b32 v19, 3, v4
  v_and_b32 v20, 4, v4
  v_lshl_or_b32 v19, v20, 1, v19
  v_and_b32 v20, 8, v4
  v_lshrrev_b32 v20, 1, v20
  v_or_b32 v19, v19, v20
  v_lshlrev_b32 v19, 4, v19
  v_lshl_add_u32 v19, v3, 9, v19
  s_lshl_b32 s32, s21, 16
  s_lshl_b32 s33, s20, 13
  s_add_u32 s32, s32, s33
  v_add_u32 v21, s32, v18
  v_add_u32 v22, s32, v19
  v_cvt_pk_bf16_f32 v168, v168, v169
  v_cvt_pk_bf16_f32 v169, v170, v171
  v_cvt_pk_bf16_f32 v170, v172, v173
  v_cvt_pk_bf16_f32 v171, v174, v175
  buffer_store_dwordx4 v[168:171], v18, s[8:11], s29 offen offset:0 sc1
  ds_write_b128 v21, v[168:171] offset:0
  v_cvt_pk_bf16_f32 v192, v192, v193
  v_cvt_pk_bf16_f32 v193, v194, v195
  v_cvt_pk_bf16_f32 v194, v196, v197
  v_cvt_pk_bf16_f32 v195, v198, v199
  buffer_store_dwordx4 v[192:195], v18, s[8:11], s29 offen offset:128 sc1
  ds_write_b128 v21, v[192:195] offset:128
  v_cvt_pk_bf16_f32 v216, v216, v217
  v_cvt_pk_bf16_f32 v217, v218, v219
  v_cvt_pk_bf16_f32 v218, v220, v221
  v_cvt_pk_bf16_f32 v219, v222, v223
  buffer_store_dwordx4 v[216:219], v18, s[8:11], s30 offen offset:0 sc1
  ds_write_b128 v21, v[216:219] offset:4096
  v_cvt_pk_bf16_f32 v240, v240, v241
  v_cvt_pk_bf16_f32 v241, v242, v243
  v_cvt_pk_bf16_f32 v242, v244, v245
  v_cvt_pk_bf16_f32 v243, v246, v247
  buffer_store_dwordx4 v[240:243], v18, s[8:11], s30 offen offset:128 sc1
  ds_write_b128 v21, v[240:243] offset:4224
  v_cvt_pk_bf16_f32 v176, v176, v177
  v_cvt_pk_bf16_f32 v177, v178, v179
  v_cvt_pk_bf16_f32 v178, v200, v201
  v_cvt_pk_bf16_f32 v179, v202, v203
  buffer_store_dwordx4 v[176:179], v19, s[8:11], s29 offen offset:2048 sc1
  ds_write_b128 v22, v[176:179] offset:2048
  v_cvt_pk_bf16_f32 v180, v180, v181
  v_cvt_pk_bf16_f32 v181, v182, v183
  v_cvt_pk_bf16_f32 v182, v204, v205
  v_cvt_pk_bf16_f32 v183, v206, v207
  buffer_store_dwordx4 v[180:183], v19, s[8:11], s29 offen offset:2304 sc1
  ds_write_b128 v22, v[180:183] offset:2304
  v_cvt_pk_bf16_f32 v224, v224, v225
  v_cvt_pk_bf16_f32 v225, v226, v227
  v_cvt_pk_bf16_f32 v226, v248, v249
  v_cvt_pk_bf16_f32 v227, v250, v251
  buffer_store_dwordx4 v[224:227], v19, s[8:11], s30 offen offset:2048 sc1
  ds_write_b128 v22, v[224:227] offset:6144
  v_cvt_pk_bf16_f32 v228, v228, v229
  v_cvt_pk_bf16_f32 v229, v230, v231
  v_cvt_pk_bf16_f32 v230, v252, v253
  v_cvt_pk_bf16_f32 v231, v254, v255
  buffer_store_dwordx4 v[228:231], v19, s[8:11], s30 offen offset:2304 sc1
  ds_write_b128 v22, v[228:231] offset:6400
  v_mul_f32 v160, s31, v160
  v_mul_f32 v161, s31, v161
  v_mul_f32 v162, s31, v162
  v_mul_f32 v163, s31, v163
  v_mul_f32 v164, s31, v164
  v_mul_f32 v165, s31, v165
  v_mul_f32 v166, s31, v166
  v_mul_f32 v167, s31, v167
  v_cvt_pk_bf16_f32 v8, v160, v161
  v_cvt_pk_bf16_f32 v9, v162, v163
  v_cvt_pk_bf16_f32 v10, v164, v165
  v_cvt_pk_bf16_f32 v11, v166, v167
  v_mul_f32 v184, s31, v184
  v_mul_f32 v185, s31, v185
  v_mul_f32 v186, s31, v186
  v_mul_f32 v187, s31, v187
  v_mul_f32 v188, s31, v188
  v_mul_f32 v189, s31, v189
  v_mul_f32 v190, s31, v190
  v_mul_f32 v191, s31, v191
  v_cvt_pk_bf16_f32 v12, v184, v185
  v_cvt_pk_bf16_f32 v13, v186, v187
  v_cvt_pk_bf16_f32 v14, v188, v189
  v_cvt_pk_bf16_f32 v15, v190, v191
  v_mul_f32 v208, s31, v208
  v_mul_f32 v209, s31, v209
  v_mul_f32 v210, s31, v210
  v_mul_f32 v211, s31, v211
  v_mul_f32 v212, s31, v212
  v_mul_f32 v213, s31, v213
  v_mul_f32 v214, s31, v214
  v_mul_f32 v215, s31, v215
  v_cvt_pk_bf16_f32 v16, v208, v209
  v_cvt_pk_bf16_f32 v17, v210, v211
  v_cvt_pk_bf16_f32 v18, v212, v213
  v_cvt_pk_bf16_f32 v19, v214, v215
  v_mul_f32 v232, s31, v232
  v_mul_f32 v233, s31, v233
  v_mul_f32 v234, s31, v234
  v_mul_f32 v235, s31, v235
  v_mul_f32 v236, s31, v236
  v_mul_f32 v237, s31, v237
  v_mul_f32 v238, s31, v238
  v_mul_f32 v239, s31, v239
  v_cvt_pk_bf16_f32 v20, v232, v233
  v_cvt_pk_bf16_f32 v21, v234, v235
  v_cvt_pk_bf16_f32 v22, v236, v237
  v_cvt_pk_bf16_f32 v23, v238, v239
  s_nop 1
  v_permlane16_swap_b32 v8, v12
  v_permlane16_swap_b32 v9, v13
  v_permlane16_swap_b32 v10, v14
  v_permlane16_swap_b32 v11, v15
  v_permlane16_swap_b32 v16, v20
  v_permlane16_swap_b32 v17, v21
  v_permlane16_swap_b32 v18, v22
  v_permlane16_swap_b32 v19, v23
  v_permlane32_swap_b32 v8, v12
  v_permlane32_swap_b32 v9, v13
  v_permlane32_swap_b32 v10, v14
  v_permlane32_swap_b32 v11, v15
  v_permlane32_swap_b32 v16, v20
  v_permlane32_swap_b32 v17, v21
  v_permlane32_swap_b32 v18, v22
  v_permlane32_swap_b32 v19, v23
  v_mov_b32 v3, 163712
  s_mov_b32 s24, 0
  s_and_b32 s27, s3, 3
  s_mul_i32 s22, s26, 66560
  s_lshl_b32 s23, s19, 1
  s_add_u32 s23, s23, s21
  s_lshl_b32 s23, s23, 11
  s_add_u32 s22, s22, s23
  s_add_u32 s22, s22, 17956864
  s_add_u32 s23, s22, 66560
  s_lshl_b32 s20, s21, 16
  v_add_u32 v84, s20, v2
  v_lshrrev_b32 v1, 2, v0
  v_lshrrev_b32 v4, 4, v0
  v_xor_b32 v1, v1, v4
  v_and_b32 v1, 1, v1
  v_and_b32 v4, 3, v0
  v_or_b32 v1, v1, v4
  v_cmp_eq_u32 vcc, 0, v1
  v_mov_b32 v4, 0x3f803f80
  s_nop 0
  v_cndmask_b32 v40, 0, v4, vcc
  v_cndmask_b32 v41, 0, v4, vcc
  v_cndmask_b32 v42, 0, v4, vcc
  v_cndmask_b32 v43, 0, v4, vcc
  s_lshl_b32 s40, s18, 9
  s_lshr_b32 s41, s19, 2
  s_lshl_b32 s41, s41, 7
  s_add_u32 s40, s40, s41
  s_lshl_b32 s27, s27, 2
  s_add_u32 s40, s40, 401408
  v_add_u32 v85, s27, v3
L_adaL_atC_main:
  v_mov_b32 v86, 0
  s_mov_b32 s33, 2
  v_mov_b32 v96, 0
  v_mov_b32 v97, 0
  v_mov_b32 v98, 0
  v_mov_b32 v99, 0
  v_mov_b32 v100, 0
  v_mov_b32 v101, 0
  v_mov_b32 v102, 0
  v_mov_b32 v103, 0
  v_mov_b32 v104, 0
  v_mov_b32 v105, 0
  v_mov_b32 v106, 0
  v_mov_b32 v107, 0
  v_mov_b32 v108, 0
  v_mov_b32 v109, 0
  v_mov_b32 v110, 0
  v_mov_b32 v111, 0
  v_mov_b32 v112, 0
  v_mov_b32 v113, 0
  v_mov_b32 v114, 0
  v_mov_b32 v115, 0
  v_mov_b32 v116, 0
  v_mov_b32 v117, 0
  v_mov_b32 v118, 0
  v_mov_b32 v119, 0
  v_mov_b32 v120, 0
  v_mov_b32 v121, 0
  v_mov_b32 v122, 0
  v_mov_b32 v123, 0
  v_mov_b32 v124, 0
  v_mov_b32 v125, 0
  v_mov_b32 v126, 0
  v_mov_b32 v127, 0
  v_mov_b32 v44, 0
  v_mov_b32 v32, 0
  v_mov_b32 v76, 0
  v_mov_b32 v45, 0
  v_mov_b32 v33, 0
  v_mov_b32 v77, 0
  v_mov_b32 v46, 0
  v_mov_b32 v34, 0
  v_mov_b32 v78, 0
  v_mov_b32 v47, 0
  v_mov_b32 v35, 0
  v_mov_b32 v79, 0
  v_mov_b32 v48, 0
  v_mov_b32 v36, 0
  v_mov_b32 v80, 0
  v_mov_b32 v49, 0
  v_mov_b32 v37, 0
  v_mov_b32 v81, 0
  v_mov_b32 v50, 0
  v_mov_b32 v38, 0
  v_mov_b32 v82, 0
  v_mov_b32 v51, 0
  v_mov_b32 v39, 0
  v_mov_b32 v83, 0
  s_mov_b32 s25, 0
  s_waitcnt lgkmcnt(0)
  s_barrier
  s_cmp_eq_u32 s24, 0
  s_cbranch_scc1 L_adaL_atC_st0
  s_mov_b32 s62, 0
L_adaL_atC_w0:
  ds_read_b32 v87, v3 offset:16
  s_add_u32 s62, s62, 1
  s_waitcnt lgkmcnt(0)
  s_cmp_gt_u32 s62, 0x1000000
  v_readfirstlane_b32 s63, v87
  s_cbranch_scc1 L_adaL_atC_w0x
  s_cmp_ge_u32 s63, 1
  s_cbranch_scc1 L_adaL_atC_w0x
  s_sleep 2
  s_branch L_adaL_atC_w0
L_adaL_atC_w0x:
L_adaL_atC_st0:
  ds_read_b128 v[68:71], v84
  ds_read_b128 v[72:75], v84 offset:1024
  ds_read_b128 v[52:55], v84 offset:4096
  ds_read_b128 v[56:59], v84 offset:5120
  ds_read_b128 v[60:63], v84 offset:2048
  ds_read_b128 v[64:67], v84 offset:3072
  s_cmp_lg_u32 s24, 0
  s_waitcnt lgkmcnt(4)
  s_cbranch_scc1 L_adaL_atC_havem
  v_mfma_f32_32x32x16_bf16 v[160:175], v[68:71], v[8:11], 0
  v_mfma_f32_32x32x16_bf16 v[160:175], v[72:75], v[12:15], v[160:175]
  v_mfma_f32_32x32x16_bf16 v[176:191], v[68:71], v[16:19], 0
  v_mfma_f32_32x32x16_bf16 v[176:191], v[72:75], v[20:23], v[176:191]
  s_nop 9
  v_max3_f32 v192, v160, v161, v162
  v_max3_f32 v192, v192, v163, v164
  v_max3_f32 v192, v192, v165, v166
  v_max3_f32 v192, v192, v167, v168
  v_max3_f32 v192, v192, v169, v170
  v_max3_f32 v192, v192, v171, v172
  v_max3_f32 v192, v192, v173, v174
  v_max_f32 v192, v192, v175
  v_mov_b32 v193, v192
  s_nop 1
  v_max3_f32 v194, v176, v177, v178
  v_max3_f32 v194, v194, v179, v180
  v_max3_f32 v194, v194, v181, v182
  v_max3_f32 v194, v194, v183, v184
  v_max3_f32 v194, v194, v185, v186
  v_max3_f32 v194, v194, v187, v188
  v_max3_f32 v194, v194, v189, v190
  v_max_f32 v194, v194, v191
  v_mov_b32 v195, v194
  s_nop 1
  v_permlane32_swap_b32 v193, v192
  v_permlane32_swap_b32 v195, v194
  v_max_f32 v192, v192, v193
  v_sub_f32 v192, 0xc2400000, v192
  v_max_f32 v194, v194, v195
  v_sub_f32 v194, 0xc2400000, v194
  v_mov_b32 v128, v192
  v_mov_b32 v129, v192
  v_mov_b32 v130, v192
  v_mov_b32 v131, v192
  v_mov_b32 v132, v192
  v_mov_b32 v133, v192
  v_mov_b32 v134, v192
  v_mov_b32 v135, v192
  v_mov_b32 v136, v192
  v_mov_b32 v137, v192
  v_mov_b32 v138, v192
  v_mov_b32 v139, v192
  v_mov_b32 v140, v192
  v_mov_b32 v141, v192
  v_mov_b32 v142, v192
  v_mov_b32 v143, v192
  v_mov_b32 v144, v194
  v_mov_b32 v145, v194
  v_mov_b32 v146, v194
  v_mov_b32 v147, v194
  v_mov_b32 v148, v194
  v_mov_b32 v149, v194
  v_mov_b32 v150, v194
  v_mov_b32 v151, v194
  v_mov_b32 v152, v194
  v_mov_b32 v153, v194
  v_mov_b32 v154, v194
  v_mov_b32 v155, v194
  v_mov_b32 v156, v194
  v_mov_b32 v157, v194
  v_mov_b32 v158, v194
  v_mov_b32 v159, v194
  v_mov_b32 v200, 0
  v_mov_b32 v201, 1
  s_mov_b64 exec, 1
  s_waitcnt vmcnt(0)
  buffer_atomic_add v201, v200, s[8:11], s58 offen sc1
  s_mov_b64 exec, -1
L_adaL_atC_havem:
  v_mfma_f32_32x32x16_bf16 v[160:175], v[68:71], v[8:11], v[128:143]
  v_mfma_f32_32x32x16_bf16 v[160:175], v[72:75], v[12:15], v[160:175]
  s_nop 10
L_adaL_atC_loop:
  v_mfma_f32_32x32x16_bf16 v[176:191], v[68:71], v[16:19], v[144:159]
  ds_write_b32 v85, v86
  v_exp_f32 v160, v160
  v_exp_f32 v161, v161
  v_exp_f32 v162, v162
  v_mfma_f32_32x32x16_bf16 v[176:191], v[72:75], v[20:23], v[176:191]
  v_add_u32 v86, 1, v86
  v_exp_f32 v163, v163
  v_exp_f32 v164, v164
  v_exp_f32 v165, v165
  v_mfma_f32_32x32x16_bf16 v[112:127], v[76:79], v[32:35], v[112:127]
  v_exp_f32 v166, v166
  v_exp_f32 v167, v167
  v_exp_f32 v168, v168
  v_mfma_f32_16x16x32_bf16 v[48:51], v[40:43], v[32:35], v[48:51]
  v_cvt_pk_bf16_f32 v24, v160, v161
  v_cvt_pk_bf16_f32 v25, v162, v163
  v_cvt_pk_bf16_f32 v26, v164, v165
  v_cvt_pk_bf16_f32 v27, v166, v167
  v_mfma_f32_32x32x16_bf16 v[112:127], v[80:83], v[36:39], v[112:127]
  s_waitcnt lgkmcnt(0)
  v_exp_f32 v169, v169
  v_exp_f32 v170, v170
  v_exp_f32 v171, v171
  v_exp_f32 v172, v172
  v_mfma_f32_16x16x32_bf16 v[48:51], v[40:43], v[36:39], v[48:51]
  v_exp_f32 v173, v173
  v_exp_f32 v174, v174
  v_exp_f32 v175, v175
  v_cvt_pk_bf16_f32 v28, v168, v169
  v_cvt_pk_bf16_f32 v29, v170, v171
  v_cvt_pk_bf16_f32 v30, v172, v173
  v_cvt_pk_bf16_f32 v31, v174, v175
  v_mfma_f32_32x32x16_bf16 v[160:175], v[52:55], v[8:11], v[128:143]
  ds_read_b128 v[68:71], v84 offset:8192
  v_exp_f32 v176, v176
  v_exp_f32 v177, v177
  v_exp_f32 v178, v178
  v_mfma_f32_32x32x16_bf16 v[160:175], v[56:59], v[12:15], v[160:175]
  ds_read_b128 v[72:75], v84 offset:9216
  v_exp_f32 v179, v179
  v_exp_f32 v180, v180
  v_exp_f32 v181, v181
  v_mfma_f32_32x32x16_bf16 v[96:111], v[60:63], v[24:27], v[96:111]
  ds_read_b128 v[76:79], v84 offset:6144
  v_exp_f32 v182, v182
  v_exp_f32 v183, v183
  v_exp_f32 v184, v184
  v_mfma_f32_16x16x32_bf16 v[44:47], v[40:43], v[24:27], v[44:47]
  v_cvt_pk_bf16_f32 v32, v176, v177
  v_cvt_pk_bf16_f32 v33, v178, v179
  v_cvt_pk_bf16_f32 v34, v180, v181
  v_cvt_pk_bf16_f32 v35, v182, v183
  v_mfma_f32_32x32x16_bf16 v[96:111], v[64:67], v[28:31], v[96:111]
  ds_read_b128 v[80:83], v84 offset:7168
  v_exp_f32 v185, v185
  v_exp_f32 v186, v186
  v_exp_f32 v187, v187
  v_exp_f32 v188, v188
  v_mfma_f32_16x16x32_bf16 v[44:47], v[40:43], v[28:31], v[44:47]
  v_exp_f32 v189, v189
  v_exp_f32 v190, v190
  v_exp_f32 v191, v191
  v_cvt_pk_bf16_f32 v36, v184, v185
  v_cvt_pk_bf16_f32 v37, v186, v187
  v_cvt_pk_bf16_f32 v38, v188, v189
  v_cvt_pk_bf16_f32 v39, v190, v191
  v_mfma_f32_32x32x16_bf16 v[176:191], v[52:55], v[16:19], v[144:159]
  v_exp_f32 v160, v160
  v_exp_f32 v161, v161
  v_exp_f32 v162, v162
  v_mfma_f32_32x32x16_bf16 v[176:191], v[56:59], v[20:23], v[176:191]
  v_exp_f32 v163, v163
  v_exp_f32 v164, v164
  v_exp_f32 v165, v165
  v_mfma_f32_32x32x16_bf16 v[112:127], v[60:63], v[32:35], v[112:127]
  v_exp_f32 v166, v166
  v_exp_f32 v167, v167
  v_exp_f32 v168, v168
  v_mfma_f32_16x16x32_bf16 v[48:51], v[40:43], v[32:35], v[48:51]
  v_cvt_pk_bf16_f32 v24, v160, v161
  v_cvt_pk_bf16_f32 v25, v162, v163
  v_cvt_pk_bf16_f32 v26, v164, v165
  v_cvt_pk_bf16_f32 v27, v166, v167
  v_mfma_f32_32x32x16_bf16 v[112:127], v[64:67], v[36:39], v[112:127]
  s_waitcnt lgkmcnt(0)
  v_exp_f32 v169, v169
  v_exp_f32 v170, v170
  v_exp_f32 v171, v171
  v_exp_f32 v172, v172
  v_mfma_f32_16x16x32_bf16 v[48:51], v[40:43], v[36:39], v[48:51]
  v_exp_f32 v173, v173
  v_exp_f32 v174, v174
  v_exp_f32 v175, v175
  v_cvt_pk_bf16_f32 v28, v168, v169
  v_cvt_pk_bf16_f32 v29, v170, v171
  v_cvt_pk_bf16_f32 v30, v172, v173
  v_cvt_pk_bf16_f32 v31, v174, v175
  v_mfma_f32_32x32x16_bf16 v[160:175], v[68:71], v[8:11], v[128:143]
  ds_read_b128 v[52:55], v84 offset:12288
  v_exp_f32 v176, v176
  v_exp_f32 v177, v177
  v_exp_f32 v178, v178
  v_mfma_f32_32x32x16_bf16 v[160:175], v[72:75], v[12:15], v[160:175]
  ds_read_b128 v[56:59], v84 offset:13312
  v_exp_f32 v179, v179
  v_exp_f32 v180, v180
  v_exp_f32 v181, v181
  v_mfma_f32_32x32x16_bf16 v[96:111], v[76:79], v[24:27], v[96:111]
  ds_read_b128 v[60:63], v84 offset:10240
  v_exp_f32 v182, v182
  v_exp_f32 v183, v183
  v_exp_f32 v184, v184
  v_mfma_f32_16x16x32_bf16 v[44:47], v[40:43], v[24:27], v[44:47]
  v_cvt_pk_bf16_f32 v32, v176, v177
  v_cvt_pk_bf16_f32 v33, v178, v179
  v_cvt_pk_bf16_f32 v34, v180, v181
  v_cvt_pk_bf16_f32 v35, v182, v183
  v_mfma_f32_32x32x16_bf16 v[96:111], v[80:83], v[28:31], v[96:111]
  ds_read_b128 v[64:67], v84 offset:11264
  v_exp_f32 v185, v185
  v_exp_f32 v186, v186
  v_exp_f32 v187, v187
  v_exp_f32 v188, v188
  v_mfma_f32_16x16x32_bf16 v[44:47], v[40:43], v[28:31], v[44:47]
  v_exp_f32 v189, v189
  v_exp_f32 v190, v190
  v_exp_f32 v191, v191
  v_cvt_pk_bf16_f32 v36, v184, v185
  v_cvt_pk_bf16_f32 v37, v186, v187
  v_cvt_pk_bf16_f32 v38, v188, v189
  v_cvt_pk_bf16_f32 v39, v190, v191
  v_mfma_f32_32x32x16_bf16 v[176:191], v[68:71], v[16:19], v[144:159]
  ds_read_b32 v87, v3 offset:16
  v_exp_f32 v160, v160
  v_exp_f32 v161, v161
  v_exp_f32 v162, v162
  v_mfma_f32_32x32x16_bf16 v[176:191], v[72:75], v[20:23], v[176:191]
  v_exp_f32 v163, v163
  v_exp_f32 v164, v164
  v_exp_f32 v165, v165
  v_mfma_f32_32x32x16_bf16 v[112:127], v[76:79], v[32:35], v[112:127]
  v_exp_f32 v166, v166
  v_exp_f32 v167, v167
  v_exp_f32 v168, v168
  v_mfma_f32_16x16x32_bf16 v[48:51], v[40:43], v[32:35], v[48:51]
  v_cvt_pk_bf16_f32 v24, v160, v161
  v_cvt_pk_bf16_f32 v25, v162, v163
  v_cvt_pk_bf16_f32 v26, v164, v165
  v_cvt_pk_bf16_f32 v27, v166, v167
  v_mfma_f32_32x32x16_bf16 v[112:127], v[80:83], v[36:39], v[112:127]
  s_waitcnt lgkmcnt(0)
  v_exp_f32 v169, v169
  v_exp_f32 v170, v170
  v_exp_f32 v171, v171
  v_exp_f32 v172, v172
  v_mfma_f32_16x16x32_bf16 v[48:51], v[40:43], v[36:39], v[48:51]
  v_readfirstlane_b32 s32, v87
  v_exp_f32 v173, v173
  v_exp_f32 v174, v174
  v_exp_f32 v175, v175
  v_cvt_pk_bf16_f32 v28, v168, v169
  v_cvt_pk_bf16_f32 v29, v170, v171
  v_cvt_pk_bf16_f32 v30, v172, v173
  v_cvt_pk_bf16_f32 v31, v174, v175
  s_cmp_lt_u32 s32, s33
  s_cbranch_scc1 L_adaL_atC_slow2
L_adaL_atC_slowr2:
  v_mfma_f32_32x32x16_bf16 v[160:175], v[52:55], v[8:11], v[128:143]
  ds_read_b128 v[68:71], v84 offset:16384
  v_exp_f32 v176, v176
  v_exp_f32 v177, v177
  v_exp_f32 v178, v178
  v_mfma_f32_32x32x16_bf16 v[160:175], v[56:59], v[12:15], v[160:175]
  ds_read_b128 v[72:75], v84 offset:17408
  v_exp_f32 v179, v179
  v_exp_f32 v180, v180
  v_exp_f32 v181, v181
  v_mfma_f32_32x32x16_bf16 v[96:111], v[60:63], v[24:27], v[96:111]
  ds_read_b128 v[76:79], v84 offset:14336
  v_exp_f32 v182, v182
  v_exp_f32 v183, v183
  v_exp_f32 v184, v184
  v_mfma_f32_16x16x32_bf16 v[44:47], v[40:43], v[24:27], v[44:47]
  v_cvt_pk_bf16_f32 v32, v176, v177
  v_cvt_pk_bf16_f32 v33, v178, v179
  v_cvt_pk_bf16_f32 v34, v180, v181
  v_cvt_pk_bf16_f32 v35, v182, v183
  v_mfma_f32_32x32x16_bf16 v[96:111], v[64:67], v[28:31], v[96:111]
  ds_read_b128 v[80:83], v84 offset:15360
  v_exp_f32 v185, v185
  v_exp_f32 v186, v186
  v_exp_f32 v187, v187
  v_exp_f32 v188, v188
  v_mfma_f32_16x16x32_bf16 v[44:47], v[40:43], v[28:31], v[44:47]
  s_add_u32 s33, s33, 1
  s_min_u32 s33, s33, 16
  v_exp_f32 v189, v189
  v_exp_f32 v190, v190
  v_exp_f32 v191, v191
  v_cvt_pk_bf16_f32 v36, v184, v185
  v_cvt_pk_bf16_f32 v37, v186, v187
  v_cvt_pk_bf16_f32 v38, v188, v189
  v_cvt_pk_bf16_f32 v39, v190, v191
  v_mfma_f32_32x32x16_bf16 v[176:191], v[52:55], v[16:19], v[144:159]
  v_exp_f32 v160, v160
  v_exp_f32 v161, v161
  v_exp_f32 v162, v162
  v_mfma_f32_32x32x16_bf16 v[176:191], v[56:59], v[20:23], v[176:191]
  v_exp_f32 v163, v163
  v_exp_f32 v164, v164
  v_exp_f32 v165, v165
  v_mfma_f32_32x32x16_bf16 v[112:127], v[60:63], v[32:35], v[112:127]
  v_exp_f32 v166, v166
  v_exp_f32 v167, v167
  v_exp_f32 v168, v168
  v_mfma_f32_16x16x32_bf16 v[48:51], v[40:43], v[32:35], v[48:51]
  v_cvt_pk_bf16_f32 v24, v160, v161
  v_cvt_pk_bf16_f32 v25, v162, v163
  v_cvt_pk_bf16_f32 v26, v164, v165
  v_cvt_pk_bf16_f32 v27, v166, v167
  v_mfma_f32_32x32x16_bf16 v[112:127], v[64:67], v[36:39], v[112:127]
  s_waitcnt lgkmcnt(0)
  v_exp_f32 v169, v169
  v_exp_f32 v170, v170
  v_exp_f32 v171, v171
  v_exp_f32 v172, v172
  v_mfma_f32_16x16x32_bf16 v[48:51], v[40:43], v[36:39], v[48:51]
  v_exp_f32 v173, v173
  v_exp_f32 v174, v174
  v_exp_f32 v175, v175
  v_cvt_pk_bf16_f32 v28, v168, v169
  v_cvt_pk_bf16_f32 v29, v170, v171
  v_cvt_pk_bf16_f32 v30, v172, v173
  v_cvt_pk_bf16_f32 v31, v174, v175
  v_mfma_f32_32x32x16_bf16 v[160:175], v[68:71], v[8:11], v[128:143]
  ds_read_b128 v[52:55], v84 offset:20480
  v_exp_f32 v176, v176
  v_exp_f32 v177, v177
  v_exp_f32 v178, v178
  v_mfma_f32_32x32x16_bf16 v[160:175], v[72:75], v[12:15], v[160:175]
  ds_read_b128 v[56:59], v84 offset:21504
  v_exp_f32 v179, v179
  v_exp_f32 v180, v180
  v_exp_f32 v181, v181
  v_mfma_f32_32x32x16_bf16 v[96:111], v[76:79], v[24:27], v[96:111]
  ds_read_b128 v[60:63], v84 offset:18432
  v_exp_f32 v182, v182
  v_exp_f32 v183, v183
  v_exp_f32 v184, v184
  v_mfma_f32_16x16x32_bf16 v[44:47], v[40:43], v[24:27], v[44:47]
  v_cvt_pk_bf16_f32 v32, v176, v177
  v_cvt_pk_bf16_f32 v33, v178, v179
  v_cvt_pk_bf16_f32 v34, v180, v181
  v_cvt_pk_bf16_f32 v35, v182, v183
  v_mfma_f32_32x32x16_bf16 v[96:111], v[80:83], v[28:31], v[96:111]
  ds_read_b128 v[64:67], v84 offset:19456
  v_exp_f32 v185, v185
  v_exp_f32 v186, v186
  v_exp_f32 v187, v187
  v_exp_f32 v188, v188
  v_mfma_f32_16x16x32_bf16 v[44:47], v[40:43], v[28:31], v[44:47]
  v_exp_f32 v189, v189
  v_exp_f32 v190, v190
  v_exp_f32 v191, v191
  v_cvt_pk_bf16_f32 v36, v184, v185
  v_cvt_pk_bf16_f32 v37, v186, v187
  v_cvt_pk_bf16_f32 v38, v188, v189
  v_cvt_pk_bf16_f32 v39, v190, v191
  v_mfma_f32_32x32x16_bf16 v[176:191], v[68:71], v[16:19], v[144:159]
  ds_write_b32 v85, v86
  v_exp_f32 v160, v160
  v_exp_f32 v161, v161
  v_exp_f32 v162, v162
  v_mfma_f32_32x32x16_bf16 v[176:191], v[72:75], v[20:23], v[176:191]
  v_add_u32 v86, 1, v86
  v_exp_f32 v163, v163
  v_exp_f32 v164, v164
  v_exp_f32 v165, v165
  v_mfma_f32_32x32x16_bf16 v[112:127], v[76:79], v[32:35], v[112:127]
  v_exp_f32 v166, v166
  v_exp_f32 v167, v167
  v_exp_f32 v168, v168
  v_mfma_f32_16x16x32_bf16 v[48:51], v[40:43], v[32:35], v[48:51]
  v_cvt_pk_bf16_f32 v24, v160, v161
  v_cvt_pk_bf16_f32 v25, v162, v163
  v_cvt_pk_bf16_f32 v26, v164, v165
  v_cvt_pk_bf16_f32 v27, v166, v167
  v_mfma_f32_32x32x16_bf16 v[112:127], v[80:83], v[36:39], v[112:127]
  s_waitcnt lgkmcnt(0)
  v_exp_f32 v169, v169
  v_exp_f32 v170, v170
  v_exp_f32 v171, v171
  v_exp_f32 v172, v172
  v_mfma_f32_16x16x32_bf16 v[48:51], v[40:43], v[36:39], v[48:51]
  v_exp_f32 v173, v173
  v_exp_f32 v174, v174
  v_exp_f32 v175, v175
  v_cvt_pk_bf16_f32 v28, v168, v169
  v_cvt_pk_bf16_f32 v29, v170, v171
  v_cvt_pk_bf16_f32 v30, v172, v173
  v_cvt_pk_bf16_f32 v31, v174, v175
  v_mfma_f32_32x32x16_bf16 v[160:175], v[52:55], v[8:11], v[128:143]
  ds_read_b128 v[68:71], v84 offset:24576
  v_exp_f32 v176, v176
  v_exp_f32 v177, v177
  v_exp_f32 v178, v178
  v_mfma_f32_32x32x16_bf16 v[160:175], v[56:59], v[12:15], v[160:175]
  ds_read_b128 v[72:75], v84 offset:25600
  v_exp_f32 v179, v179
  v_exp_f32 v180, v180
  v_exp_f32 v181, v181
  v_mfma_f32_32x32x16_bf16 v[96:111], v[60:63], v[24:27], v[96:111]
  ds_read_b128 v[76:79], v84 offset:22528
  v_exp_f32 v182, v182
  v_exp_f32 v183, v183
  v_exp_f32 v184, v184
  v_mfma_f32_16x16x32_bf16 v[44:47], v[40:43], v[24:27], v[44:47]
  v_cvt_pk_bf16_f32 v32, v176, v177
  v_cvt_pk_bf16_f32 v33, v178, v179
  v_cvt_pk_bf16_f32 v34, v180, v181
  v_cvt_pk_bf16_f32 v35, v182, v183
  v_mfma_f32_32x32x16_bf16 v[96:111], v[64:67], v[28:31], v[96:111]
  ds_read_b128 v[80:83], v84 offset:23552
  v_exp_f32 v185, v185
  v_exp_f32 v186, v186
  v_exp_f32 v187, v187
  v_exp_f32 v188, v188
  v_mfma_f32_16x16x32_bf16 v[44:47], v[40:43], v[28:31], v[44:47]
  v_exp_f32 v189, v189
  v_exp_f32 v190, v190
  v_exp_f32 v191, v191
  v_cvt_pk_bf16_f32 v36, v184, v185
  v_cvt_pk_bf16_f32 v37, v186, v187
  v_cvt_pk_bf16_f32 v38, v188, v189
  v_cvt_pk_bf16_f32 v39, v190, v191
  v_mfma_f32_32x32x16_bf16 v[176:191], v[52:55], v[16:19], v[144:159]
  v_exp_f32 v160, v160
  v_exp_f32 v161, v161
  v_exp_f32 v162, v162
  v_mfma_f32_32x32x16_bf16 v[176:191], v[56:59], v[20:23], v[176:191]
  v_exp_f32 v163, v163
  v_exp_f32 v164, v164
  v_exp_f32 v165, v165
  v_mfma_f32_32x32x16_bf16 v[112:127], v[60:63], v[32:35], v[112:127]
  v_exp_f32 v166, v166
  v_exp_f32 v167, v167
  v_exp_f32 v168, v168
  v_mfma_f32_16x16x32_bf16 v[48:51], v[40:43], v[32:35], v[48:51]
  v_cvt_pk_bf16_f32 v24, v160, v161
  v_cvt_pk_bf16_f32 v25, v162, v163
  v_cvt_pk_bf16_f32 v26, v164, v165
  v_cvt_pk_bf16_f32 v27, v166, v167
  v_mfma_f32_32x32x16_bf16 v[112:127], v[64:67], v[36:39], v[112:127]
  s_waitcnt lgkmcnt(0)
  v_exp_f32 v169, v169
  v_exp_f32 v170, v170
  v_exp_f32 v171, v171
  v_exp_f32 v172, v172
  v_mfma_f32_16x16x32_bf16 v[48:51], v[40:43], v[36:39], v[48:51]
  v_exp_f32 v173, v173
  v_exp_f32 v174, v174
  v_exp_f32 v175, v175
  v_cvt_pk_bf16_f32 v28, v168, v169
  v_cvt_pk_bf16_f32 v29, v170, v171
  v_cvt_pk_bf16_f32 v30, v172, v173
  v_cvt_pk_bf16_f32 v31, v174, v175
  v_mfma_f32_32x32x16_bf16 v[160:175], v[68:71], v[8:11], v[128:143]
  ds_read_b128 v[52:55], v84 offset:28672
  v_exp_f32 v176, v176
  v_exp_f32 v177, v177
  v_exp_f32 v178, v178
  v_mfma_f32_32x32x16_bf16 v[160:175], v[72:75], v[12:15], v[160:175]
  ds_read_b128 v[56:59], v84 offset:29696
  v_exp_f32 v179, v179
  v_exp_f32 v180, v180
  v_exp_f32 v181, v181
  v_mfma_f32_32x32x16_bf16 v[96:111], v[76:79], v[24:27], v[96:111]
  ds_read_b128 v[60:63], v84 offset:26624
  v_exp_f32 v182, v182
  v_exp_f32 v183, v183
  v_exp_f32 v184, v184
  v_mfma_f32_16x16x32_bf16 v[44:47], v[40:43], v[24:27], v[44:47]
  v_cvt_pk_bf16_f32 v32, v176, v177
  v_cvt_pk_bf16_f32 v33, v178, v179
  v_cvt_pk_bf16_f32 v34, v180, v181
  v_cvt_pk_bf16_f32 v35, v182, v183
  v_mfma_f32_32x32x16_bf16 v[96:111], v[80:83], v[28:31], v[96:111]
  ds_read_b128 v[64:67], v84 offset:27648
  v_exp_f32 v185, v185
  v_exp_f32 v186, v186
  v_exp_f32 v187, v187
  v_exp_f32 v188, v188
  v_mfma_f32_16x16x32_bf16 v[44:47], v[40:43], v[28:31], v[44:47]
  v_exp_f32 v189, v189
  v_exp_f32 v190, v190
  v_exp_f32 v191, v191
  v_cvt_pk_bf16_f32 v36, v184, v185
  v_cvt_pk_bf16_f32 v37, v186, v187
  v_cvt_pk_bf16_f32 v38, v188, v189
  v_cvt_pk_bf16_f32 v39, v190, v191
  v_mfma_f32_32x32x16_bf16 v[176:191], v[68:71], v[16:19], v[144:159]
  ds_read_b32 v87, v3 offset:16
  v_exp_f32 v160, v160
  v_exp_f32 v161, v161
  v_exp_f32 v162, v162
  v_mfma_f32_32x32x16_bf16 v[176:191], v[72:75], v[20:23], v[176:191]
  v_exp_f32 v163, v163
  v_exp_f32 v164, v164
  v_exp_f32 v165, v165
  v_mfma_f32_32x32x16_bf16 v[112:127], v[76:79], v[32:35], v[112:127]
  v_exp_f32 v166, v166
  v_exp_f32 v167, v167
  v_exp_f32 v168, v168
  v_mfma_f32_16x16x32_bf16 v[48:51], v[40:43], v[32:35], v[48:51]
  v_cvt_pk_bf16_f32 v24, v160, v161
  v_cvt_pk_bf16_f32 v25, v162, v163
  v_cvt_pk_bf16_f32 v26, v164, v165
  v_cvt_pk_bf16_f32 v27, v166, v167
  v_mfma_f32_32x32x16_bf16 v[112:127], v[80:83], v[36:39], v[112:127]
  s_waitcnt lgkmcnt(0)
  v_exp_f32 v169, v169
  v_exp_f32 v170, v170
  v_exp_f32 v171, v171
  v_exp_f32 v172, v172
  v_mfma_f32_16x16x32_bf16 v[48:51], v[40:43], v[36:39], v[48:51]
  v_readfirstlane_b32 s32, v87
  v_exp_f32 v173, v173
  v_exp_f32 v174, v174
  v_exp_f32 v175, v175
  v_cvt_pk_bf16_f32 v28, v168, v169
  v_cvt_pk_bf16_f32 v29, v170, v171
  v_cvt_pk_bf16_f32 v30, v172, v173
  v_cvt_pk_bf16_f32 v31, v174, v175
  s_cmp_lt_u32 s32, s33
  s_cbranch_scc1 L_adaL_atC_slow6
L_adaL_atC_slowr6:
  v_mfma_f32_32x32x16_bf16 v[160:175], v[52:55], v[8:11], v[128:143]
  ds_read_b128 v[68:71], v84 offset:32768
  v_exp_f32 v176, v176
  v_exp_f32 v177, v177
  v_exp_f32 v178, v178
  v_mfma_f32_32x32x16_bf16 v[160:175], v[56:59], v[12:15], v[160:175]
  ds_read_b128 v[72:75], v84 offset:33792
  v_exp_f32 v179, v179
  v_exp_f32 v180, v180
  v_exp_f32 v181, v181
  v_mfma_f32_32x32x16_bf16 v[96:111], v[60:63], v[24:27], v[96:111]
  ds_read_b128 v[76:79], v84 offset:30720
  v_exp_f32 v182, v182
  v_exp_f32 v183, v183
  v_exp_f32 v184, v184
  v_mfma_f32_16x16x32_bf16 v[44:47], v[40:43], v[24:27], v[44:47]
  v_cvt_pk_bf16_f32 v32, v176, v177
  v_cvt_pk_bf16_f32 v33, v178, v179
  v_cvt_pk_bf16_f32 v34, v180, v181
  v_cvt_pk_bf16_f32 v35, v182, v183
  v_mfma_f32_32x32x16_bf16 v[96:111], v[64:67], v[28:31], v[96:111]
  ds_read_b128 v[80:83], v84 offset:31744
  v_exp_f32 v185, v185
  v_exp_f32 v186, v186
  v_exp_f32 v187, v187
  v_exp_f32 v188, v188
  v_mfma_f32_16x16x32_bf16 v[44:47], v[40:43], v[28:31], v[44:47]
  s_add_u32 s33, s33, 1
  s_min_u32 s33, s33, 16
  v_exp_f32 v189, v189
  v_exp_f32 v190, v190
  v_exp_f32 v191, v191
  v_cvt_pk_bf16_f32 v36, v184, v185
  v_cvt_pk_bf16_f32 v37, v186, v187
  v_cvt_pk_bf16_f32 v38, v188, v189
  v_cvt_pk_bf16_f32 v39, v190, v191
  v_mfma_f32_32x32x16_bf16 v[176:191], v[52:55], v[16:19], v[144:159]
  v_exp_f32 v160, v160
  v_exp_f32 v161, v161
  v_exp_f32 v162, v162
  v_mfma_f32_32x32x16_bf16 v[176:191], v[56:59], v[20:23], v[176:191]
  v_exp_f32 v163, v163
  v_exp_f32 v164, v164
  v_exp_f32 v165, v165
  v_mfma_f32_32x32x16_bf16 v[112:127], v[60:63], v[32:35], v[112:127]
  v_exp_f32 v166, v166
  v_exp_f32 v167, v167
  v_exp_f32 v168, v168
  v_mfma_f32_16x16x32_bf16 v[48:51], v[40:43], v[32:35], v[48:51]
  v_cvt_pk_bf16_f32 v24, v160, v161
  v_cvt_pk_bf16_f32 v25, v162, v163
  v_cvt_pk_bf16_f32 v26, v164, v165
  v_cvt_pk_bf16_f32 v27, v166, v167
  v_mfma_f32_32x32x16_bf16 v[112:127], v[64:67], v[36:39], v[112:127]
  s_waitcnt lgkmcnt(0)
  v_exp_f32 v169, v169
  v_exp_f32 v170, v170
  v_exp_f32 v171, v171
  v_exp_f32 v172, v172
  v_mfma_f32_16x16x32_bf16 v[48:51], v[40:43], v[36:39], v[48:51]
  v_exp_f32 v173, v173
  v_exp_f32 v174, v174
  v_exp_f32 v175, v175
  v_cvt_pk_bf16_f32 v28, v168, v169
  v_cvt_pk_bf16_f32 v29, v170, v171
  v_cvt_pk_bf16_f32 v30, v172, v173
  v_cvt_pk_bf16_f32 v31, v174, v175
  v_mfma_f32_32x32x16_bf16 v[160:175], v[68:71], v[8:11], v[128:143]
  ds_read_b128 v[52:55], v84 offset:36864
  v_exp_f32 v176, v176
  v_exp_f32 v177, v177
  v_exp_f32 v178, v178
  v_mfma_f32_32x32x16_bf16 v[160:175], v[72:75], v[12:15], v[160:175]
  ds_read_b128 v[56:59], v84 offset:37888
  v_exp_f32 v179, v179
  v_exp_f32 v180, v180
  v_exp_f32 v181, v181
  v_mfma_f32_32x32x16_bf16 v[96:111], v[76:79], v[24:27], v[96:111]
  ds_read_b128 v[60:63], v84 offset:34816
  v_exp_f32 v182, v182
  v_exp_f32 v183, v183
  v_exp_f32 v184, v184
  v_mfma_f32_16x16x32_bf16 v[44:47], v[40:43], v[24:27], v[44:47]
  v_cvt_pk_bf16_f32 v32, v176, v177
  v_cvt_pk_bf16_f32 v33, v178, v179
  v_cvt_pk_bf16_f32 v34, v180, v181
  v_cvt_pk_bf16_f32 v35, v182, v183
  v_mfma_f32_32x32x16_bf16 v[96:111], v[80:83], v[28:31], v[96:111]
  ds_read_b128 v[64:67], v84 offset:35840
  v_exp_f32 v185, v185
  v_exp_f32 v186, v186
  v_exp_f32 v187, v187
  v_exp_f32 v188, v188
  v_mfma_f32_16x16x32_bf16 v[44:47], v[40:43], v[28:31], v[44:47]
  v_exp_f32 v189, v189
  v_exp_f32 v190, v190
  v_exp_f32 v191, v191
  v_cvt_pk_bf16_f32 v36, v184, v185
  v_cvt_pk_bf16_f32 v37, v186, v187
  v_cvt_pk_bf16_f32 v38, v188, v189
  v_cvt_pk_bf16_f32 v39, v190, v191
  v_mfma_f32_32x32x16_bf16 v[176:191], v[68:71], v[16:19], v[144:159]
  ds_write_b32 v85, v86
  v_exp_f32 v160, v160
  v_exp_f32 v161, v161
  v_exp_f32 v162, v162
  v_mfma_f32_32x32x16_bf16 v[176:191], v[72:75], v[20:23], v[176:191]
  v_add_u32 v86, 1, v86
  v_exp_f32 v163, v163
  v_exp_f32 v164, v164
  v_exp_f32 v165, v165
  v_mfma_f32_32x32x16_bf16 v[112:127], v[76:79], v[32:35], v[112:127]
  v_exp_f32 v166, v166
  v_exp_f32 v167, v167
  v_exp_f32 v168, v168
  v_mfma_f32_16x16x32_bf16 v[48:51], v[40:43], v[32:35], v[48:51]
  v_cvt_pk_bf16_f32 v24, v160, v161
  v_cvt_pk_bf16_f32 v25, v162, v163
  v_cvt_pk_bf16_f32 v26, v164, v165
  v_cvt_pk_bf16_f32 v27, v166, v167
  v_mfma_f32_32x32x16_bf16 v[112:127], v[80:83], v[36:39], v[112:127]
  s_waitcnt lgkmcnt(0)
  v_exp_f32 v169, v169
  v_exp_f32 v170, v170
  v_exp_f32 v171, v171
  v_exp_f32 v172, v172
  v_mfma_f32_16x16x32_bf16 v[48:51], v[40:43], v[36:39], v[48:51]
  v_exp_f32 v173, v173
  v_exp_f32 v174, v174
  v_exp_f32 v175, v175
  v_cvt_pk_bf16_f32 v28, v168, v169
  v_cvt_pk_bf16_f32 v29, v170, v171
  v_cvt_pk_bf16_f32 v30, v172, v173
  v_cvt_pk_bf16_f32 v31, v174, v175
  v_mfma_f32_32x32x16_bf16 v[160:175], v[52:55], v[8:11], v[128:143]
  ds_read_b128 v[68:71], v84 offset:40960
  v_exp_f32 v176, v176
  v_exp_f32 v177, v177
  v_exp_f32 v178, v178
  v_mfma_f32_32x32x16_bf16 v[160:175], v[56:59], v[12:15], v[160:175]
  ds_read_b128 v[72:75], v84 offset:41984
  v_exp_f32 v179, v179
  v_exp_f32 v180, v180
  v_exp_f32 v181, v181
  v_mfma_f32_32x32x16_bf16 v[96:111], v[60:63], v[24:27], v[96:111]
  ds_read_b128 v[76:79], v84 offset:38912
  v_exp_f32 v182, v182
  v_exp_f32 v183, v183
  v_exp_f32 v184, v184
  v_mfma_f32_16x16x32_bf16 v[44:47], v[40:43], v[24:27], v[44:47]
  v_cvt_pk_bf16_f32 v32, v176, v177
  v_cvt_pk_bf16_f32 v33, v178, v179
  v_cvt_pk_bf16_f32 v34, v180, v181
  v_cvt_pk_bf16_f32 v35, v182, v183
  v_mfma_f32_32x32x16_bf16 v[96:111], v[64:67], v[28:31], v[96:111]
  ds_read_b128 v[80:83], v84 offset:39936
  v_exp_f32 v185, v185
  v_exp_f32 v186, v186
  v_exp_f32 v187, v187
  v_exp_f32 v188, v188
  v_mfma_f32_16x16x32_bf16 v[44:47], v[40:43], v[28:31], v[44:47]
  v_exp_f32 v189, v189
  v_exp_f32 v190, v190
  v_exp_f32 v191, v191
  v_cvt_pk_bf16_f32 v36, v184, v185
  v_cvt_pk_bf16_f32 v37, v186, v187
  v_cvt_pk_bf16_f32 v38, v188, v189
  v_cvt_pk_bf16_f32 v39, v190, v191
  v_mfma_f32_32x32x16_bf16 v[176:191], v[52:55], v[16:19], v[144:159]
  v_exp_f32 v160, v160
  v_exp_f32 v161, v161
  v_exp_f32 v162, v162
  v_mfma_f32_32x32x16_bf16 v[176:191], v[56:59], v[20:23], v[176:191]
  v_exp_f32 v163, v163
  v_exp_f32 v164, v164
  v_exp_f32 v165, v165
  v_mfma_f32_32x32x16_bf16 v[112:127], v[60:63], v[32:35], v[112:127]
  v_exp_f32 v166, v166
  v_exp_f32 v167, v167
  v_exp_f32 v168, v168
  v_mfma_f32_16x16x32_bf16 v[48:51], v[40:43], v[32:35], v[48:51]
  v_cvt_pk_bf16_f32 v24, v160, v161
  v_cvt_pk_bf16_f32 v25, v162, v163
  v_cvt_pk_bf16_f32 v26, v164, v165
  v_cvt_pk_bf16_f32 v27, v166, v167
  v_mfma_f32_32x32x16_bf16 v[112:127], v[64:67], v[36:39], v[112:127]
  s_waitcnt lgkmcnt(0)
  v_exp_f32 v169, v169
  v_exp_f32 v170, v170
  v_exp_f32 v171, v171
  v_exp_f32 v172, v172
  v_mfma_f32_16x16x32_bf16 v[48:51], v[40:43], v[36:39], v[48:51]
  v_exp_f32 v173, v173
  v_exp_f32 v174, v174
  v_exp_f32 v175, v175
  v_cvt_pk_bf16_f32 v28, v168, v169
  v_cvt_pk_bf16_f32 v29, v170, v171
  v_cvt_pk_bf16_f32 v30, v172, v173
  v_cvt_pk_bf16_f32 v31, v174, v175
  v_mfma_f32_32x32x16_bf16 v[160:175], v[68:71], v[8:11], v[128:143]
  ds_read_b128 v[52:55], v84 offset:45056
  v_exp_f32 v176, v176
  v_exp_f32 v177, v177
  v_exp_f32 v178, v178
  v_mfma_f32_32x32x16_bf16 v[160:175], v[72:75], v[12:15], v[160:175]
  ds_read_b128 v[56:59], v84 offset:46080
  v_exp_f32 v179, v179
  v_exp_f32 v180, v180
  v_exp_f32 v181, v181
  v_mfma_f32_32x32x16_bf16 v[96:111], v[76:79], v[24:27], v[96:111]
  ds_read_b128 v[60:63], v84 offset:43008
  v_exp_f32 v182, v182
  v_exp_f32 v183, v183
  v_exp_f32 v184, v184
  v_mfma_f32_16x16x32_bf16 v[44:47], v[40:43], v[24:27], v[44:47]
  v_cvt_pk_bf16_f32 v32, v176, v177
  v_cvt_pk_bf16_f32 v33, v178, v179
  v_cvt_pk_bf16_f32 v34, v180, v181
  v_cvt_pk_bf16_f32 v35, v182, v183
  v_mfma_f32_32x32x16_bf16 v[96:111], v[80:83], v[28:31], v[96:111]
  ds_read_b128 v[64:67], v84 offset:44032
  v_exp_f32 v185, v185
  v_exp_f32 v186, v186
  v_exp_f32 v187, v187
  v_exp_f32 v188, v188
  v_mfma_f32_16x16x32_bf16 v[44:47], v[40:43], v[28:31], v[44:47]
  v_exp_f32 v189, v189
  v_exp_f32 v190, v190
  v_exp_f32 v191, v191
  v_cvt_pk_bf16_f32 v36, v184, v185
  v_cvt_pk_bf16_f32 v37, v186, v187
  v_cvt_pk_bf16_f32 v38, v188, v189
  v_cvt_pk_bf16_f32 v39, v190, v191
  v_mfma_f32_32x32x16_bf16 v[176:191], v[68:71], v[16:19], v[144:159]
  ds_read_b32 v87, v3 offset:16
  v_exp_f32 v160, v160
  v_exp_f32 v161, v161
  v_exp_f32 v162, v162
  v_mfma_f32_32x32x16_bf16 v[176:191], v[72:75], v[20:23], v[176:191]
  v_exp_f32 v163, v163
  v_exp_f32 v164, v164
  v_exp_f32 v165, v165
  v_mfma_f32_32x32x16_bf16 v[112:127], v[76:79], v[32:35], v[112:127]
  v_exp_f32 v166, v166
  v_exp_f32 v167, v167
  v_exp_f32 v168, v168
  v_mfma_f32_16x16x32_bf16 v[48:51], v[40:43], v[32:35], v[48:51]
  v_cvt_pk_bf16_f32 v24, v160, v161
  v_cvt_pk_bf16_f32 v25, v162, v163
  v_cvt_pk_bf16_f32 v26, v164, v165
  v_cvt_pk_bf16_f32 v27, v166, v167
  v_mfma_f32_32x32x16_bf16 v[112:127], v[80:83], v[36:39], v[112:127]
  s_waitcnt lgkmcnt(0)
  v_exp_f32 v169, v169
  v_exp_f32 v170, v170
  v_exp_f32 v171, v171
  v_exp_f32 v172, v172
  v_mfma_f32_16x16x32_bf16 v[48:51], v[40:43], v[36:39], v[48:51]
  v_readfirstlane_b32 s32, v87
  v_exp_f32 v173, v173
  v_exp_f32 v174, v174
  v_exp_f32 v175, v175
  v_cvt_pk_bf16_f32 v28, v168, v169
  v_cvt_pk_bf16_f32 v29, v170, v171
  v_cvt_pk_bf16_f32 v30, v172, v173
  v_cvt_pk_bf16_f32 v31, v174, v175
  s_cmp_lt_u32 s32, s33
  s_cbranch_scc1 L_adaL_atC_slow10
L_adaL_atC_slowr10:
  v_mfma_f32_32x32x16_bf16 v[160:175], v[52:55], v[8:11], v[128:143]
  ds_read_b128 v[68:71], v84 offset:49152
  v_exp_f32 v176, v176
  v_exp_f32 v177, v177
  v_exp_f32 v178, v178
  v_mfma_f32_32x32x16_bf16 v[160:175], v[56:59], v[12:15], v[160:175]
  ds_read_b128 v[72:75], v84 offset:50176
  v_exp_f32 v179, v179
  v_exp_f32 v180, v180
  v_exp_f32 v181, v181
  v_mfma_f32_32x32x16_bf16 v[96:111], v[60:63], v[24:27], v[96:111]
  ds_read_b128 v[76:79], v84 offset:47104
  v_exp_f32 v182, v182
  v_exp_f32 v183, v183
  v_exp_f32 v184, v184
  v_mfma_f32_16x16x32_bf16 v[44:47], v[40:43], v[24:27], v[44:47]
  v_cvt_pk_bf16_f32 v32, v176, v177
  v_cvt_pk_bf16_f32 v33, v178, v179
  v_cvt_pk_bf16_f32 v34, v180, v181
  v_cvt_pk_bf16_f32 v35, v182, v183
  v_mfma_f32_32x32x16_bf16 v[96:111], v[64:67], v[28:31], v[96:111]
  ds_read_b128 v[80:83], v84 offset:48128
  v_exp_f32 v185, v185
  v_exp_f32 v186, v186
  v_exp_f32 v187, v187
  v_exp_f32 v188, v188
  v_mfma_f32_16x16x32_bf16 v[44:47], v[40:43], v[28:31], v[44:47]
  s_add_u32 s33, s33, 1
  s_min_u32 s33, s33, 16
  v_exp_f32 v189, v189
  v_exp_f32 v190, v190
  v_exp_f32 v191, v191
  v_cvt_pk_bf16_f32 v36, v184, v185
  v_cvt_pk_bf16_f32 v37, v186, v187
  v_cvt_pk_bf16_f32 v38, v188, v189
  v_cvt_pk_bf16_f32 v39, v190, v191
  v_mfma_f32_32x32x16_bf16 v[176:191], v[52:55], v[16:19], v[144:159]
  v_exp_f32 v160, v160
  v_exp_f32 v161, v161
  v_exp_f32 v162, v162
  v_mfma_f32_32x32x16_bf16 v[176:191], v[56:59], v[20:23], v[176:191]
  v_exp_f32 v163, v163
  v_exp_f32 v164, v164
  v_exp_f32 v165, v165
  v_mfma_f32_32x32x16_bf16 v[112:127], v[60:63], v[32:35], v[112:127]
  v_exp_f32 v166, v166
  v_exp_f32 v167, v167
  v_exp_f32 v168, v168
  v_mfma_f32_16x16x32_bf16 v[48:51], v[40:43], v[32:35], v[48:51]
  v_cvt_pk_bf16_f32 v24, v160, v161
  v_cvt_pk_bf16_f32 v25, v162, v163
  v_cvt_pk_bf16_f32 v26, v164, v165
  v_cvt_pk_bf16_f32 v27, v166, v167
  v_mfma_f32_32x32x16_bf16 v[112:127], v[64:67], v[36:39], v[112:127]
  s_waitcnt lgkmcnt(0)
  v_exp_f32 v169, v169
  v_exp_f32 v170, v170
  v_exp_f32 v171, v171
  v_exp_f32 v172, v172
  v_mfma_f32_16x16x32_bf16 v[48:51], v[40:43], v[36:39], v[48:51]
  v_exp_f32 v173, v173
  v_exp_f32 v174, v174
  v_exp_f32 v175, v175
  v_cvt_pk_bf16_f32 v28, v168, v169
  v_cvt_pk_bf16_f32 v29, v170, v171
  v_cvt_pk_bf16_f32 v30, v172, v173
  v_cvt_pk_bf16_f32 v31, v174, v175
  v_mfma_f32_32x32x16_bf16 v[160:175], v[68:71], v[8:11], v[128:143]
  ds_read_b128 v[52:55], v84 offset:53248
  v_exp_f32 v176, v176
  v_exp_f32 v177, v177
  v_exp_f32 v178, v178
  v_mfma_f32_32x32x16_bf16 v[160:175], v[72:75], v[12:15], v[160:175]
  ds_read_b128 v[56:59], v84 offset:54272
  v_exp_f32 v179, v179
  v_exp_f32 v180, v180
  v_exp_f32 v181, v181
  v_mfma_f32_32x32x16_bf16 v[96:111], v[76:79], v[24:27], v[96:111]
  ds_read_b128 v[60:63], v84 offset:51200
  v_exp_f32 v182, v182
  v_exp_f32 v183, v183
  v_exp_f32 v184, v184
  v_mfma_f32_16x16x32_bf16 v[44:47], v[40:43], v[24:27], v[44:47]
  v_cvt_pk_bf16_f32 v32, v176, v177
  v_cvt_pk_bf16_f32 v33, v178, v179
  v_cvt_pk_bf16_f32 v34, v180, v181
  v_cvt_pk_bf16_f32 v35, v182, v183
  v_mfma_f32_32x32x16_bf16 v[96:111], v[80:83], v[28:31], v[96:111]
  ds_read_b128 v[64:67], v84 offset:52224
  v_exp_f32 v185, v185
  v_exp_f32 v186, v186
  v_exp_f32 v187, v187
  v_exp_f32 v188, v188
  v_mfma_f32_16x16x32_bf16 v[44:47], v[40:43], v[28:31], v[44:47]
  v_exp_f32 v189, v189
  v_exp_f32 v190, v190
  v_exp_f32 v191, v191
  v_cvt_pk_bf16_f32 v36, v184, v185
  v_cvt_pk_bf16_f32 v37, v186, v187
  v_cvt_pk_bf16_f32 v38, v188, v189
  v_cvt_pk_bf16_f32 v39, v190, v191
  v_mfma_f32_32x32x16_bf16 v[176:191], v[68:71], v[16:19], v[144:159]
  ds_write_b32 v85, v86
  v_exp_f32 v160, v160
  v_exp_f32 v161, v161
  v_exp_f32 v162, v162
  v_mfma_f32_32x32x16_bf16 v[176:191], v[72:75], v[20:23], v[176:191]
  v_add_u32 v86, 1, v86
  v_exp_f32 v163, v163
  v_exp_f32 v164, v164
  v_exp_f32 v165, v165
  v_mfma_f32_32x32x16_bf16 v[112:127], v[76:79], v[32:35], v[112:127]
  v_exp_f32 v166, v166
  v_exp_f32 v167, v167
  v_exp_f32 v168, v168
  v_mfma_f32_16x16x32_bf16 v[48:51], v[40:43], v[32:35], v[48:51]
  v_cvt_pk_bf16_f32 v24, v160, v161
  v_cvt_pk_bf16_f32 v25, v162, v163
  v_cvt_pk_bf16_f32 v26, v164, v165
  v_cvt_pk_bf16_f32 v27, v166, v167
  v_mfma_f32_32x32x16_bf16 v[112:127], v[80:83], v[36:39], v[112:127]
  s_waitcnt lgkmcnt(0)
  v_exp_f32 v169, v169
  v_exp_f32 v170, v170
  v_exp_f32 v171, v171
  v_exp_f32 v172, v172
  v_mfma_f32_16x16x32_bf16 v[48:51], v[40:43], v[36:39], v[48:51]
  v_exp_f32 v173, v173
  v_exp_f32 v174, v174
  v_exp_f32 v175, v175
  v_cvt_pk_bf16_f32 v28, v168, v169
  v_cvt_pk_bf16_f32 v29, v170, v171
  v_cvt_pk_bf16_f32 v30, v172, v173
  v_cvt_pk_bf16_f32 v31, v174, v175
  v_mfma_f32_32x32x16_bf16 v[160:175], v[52:55], v[8:11], v[128:143]
  ds_read_b128 v[68:71], v84 offset:57344
  v_exp_f32 v176, v176
  v_exp_f32 v177, v177
  v_exp_f32 v178, v178
  v_mfma_f32_32x32x16_bf16 v[160:175], v[56:59], v[12:15], v[160:175]
  ds_read_b128 v[72:75], v84 offset:58368
  v_exp_f32 v179, v179
  v_exp_f32 v180, v180
  v_exp_f32 v181, v181
  v_mfma_f32_32x32x16_bf16 v[96:111], v[60:63], v[24:27], v[96:111]
  ds_read_b128 v[76:79], v84 offset:55296
  v_exp_f32 v182, v182
  v_exp_f32 v183, v183
  v_exp_f32 v184, v184
  v_mfma_f32_16x16x32_bf16 v[44:47], v[40:43], v[24:27], v[44:47]
  v_cvt_pk_bf16_f32 v32, v176, v177
  v_cvt_pk_bf16_f32 v33, v178, v179
  v_cvt_pk_bf16_f32 v34, v180, v181
  v_cvt_pk_bf16_f32 v35, v182, v183
  v_mfma_f32_32x32x16_bf16 v[96:111], v[64:67], v[28:31], v[96:111]
  ds_read_b128 v[80:83], v84 offset:56320
  v_exp_f32 v185, v185
  v_exp_f32 v186, v186
  v_exp_f32 v187, v187
  v_exp_f32 v188, v188
  v_mfma_f32_16x16x32_bf16 v[44:47], v[40:43], v[28:31], v[44:47]
  v_exp_f32 v189, v189
  v_exp_f32 v190, v190
  v_exp_f32 v191, v191
  v_cvt_pk_bf16_f32 v36, v184, v185
  v_cvt_pk_bf16_f32 v37, v186, v187
  v_cvt_pk_bf16_f32 v38, v188, v189
  v_cvt_pk_bf16_f32 v39, v190, v191
  v_mfma_f32_32x32x16_bf16 v[176:191], v[52:55], v[16:19], v[144:159]
  v_exp_f32 v160, v160
  v_exp_f32 v161, v161
  v_exp_f32 v162, v162
  v_mfma_f32_32x32x16_bf16 v[176:191], v[56:59], v[20:23], v[176:191]
  v_exp_f32 v163, v163
  v_exp_f32 v164, v164
  v_exp_f32 v165, v165
  v_mfma_f32_32x32x16_bf16 v[112:127], v[60:63], v[32:35], v[112:127]
  v_exp_f32 v166, v166
  v_exp_f32 v167, v167
  v_exp_f32 v168, v168
  v_mfma_f32_16x16x32_bf16 v[48:51], v[40:43], v[32:35], v[48:51]
  v_cvt_pk_bf16_f32 v24, v160, v161
  v_cvt_pk_bf16_f32 v25, v162, v163
  v_cvt_pk_bf16_f32 v26, v164, v165
  v_cvt_pk_bf16_f32 v27, v166, v167
  v_mfma_f32_32x32x16_bf16 v[112:127], v[64:67], v[36:39], v[112:127]
  s_waitcnt lgkmcnt(0)
  v_exp_f32 v169, v169
  v_exp_f32 v170, v170
  v_exp_f32 v171, v171
  v_exp_f32 v172, v172
  v_mfma_f32_16x16x32_bf16 v[48:51], v[40:43], v[36:39], v[48:51]
  v_exp_f32 v173, v173
  v_exp_f32 v174, v174
  v_exp_f32 v175, v175
  v_cvt_pk_bf16_f32 v28, v168, v169
  v_cvt_pk_bf16_f32 v29, v170, v171
  v_cvt_pk_bf16_f32 v30, v172, v173
  v_cvt_pk_bf16_f32 v31, v174, v175
  v_mfma_f32_32x32x16_bf16 v[160:175], v[68:71], v[8:11], v[128:143]
  ds_read_b128 v[52:55], v84 offset:61440
  v_exp_f32 v176, v176
  v_exp_f32 v177, v177
  v_exp_f32 v178, v178
  v_mfma_f32_32x32x16_bf16 v[160:175], v[72:75], v[12:15], v[160:175]
  ds_read_b128 v[56:59], v84 offset:62464
  v_exp_f32 v179, v179
  v_exp_f32 v180, v180
  v_exp_f32 v181, v181
  v_mfma_f32_32x32x16_bf16 v[96:111], v[76:79], v[24:27], v[96:111]
  ds_read_b128 v[60:63], v84 offset:59392
  v_exp_f32 v182, v182
  v_exp_f32 v183, v183
  v_exp_f32 v184, v184
  v_mfma_f32_16x16x32_bf16 v[44:47], v[40:43], v[24:27], v[44:47]
  v_cvt_pk_bf16_f32 v32, v176, v177
  v_cvt_pk_bf16_f32 v33, v178, v179
  v_cvt_pk_bf16_f32 v34, v180, v181
  v_cvt_pk_bf16_f32 v35, v182, v183
  v_mfma_f32_32x32x16_bf16 v[96:111], v[80:83], v[28:31], v[96:111]
  ds_read_b128 v[64:67], v84 offset:60416
  v_exp_f32 v185, v185
  v_exp_f32 v186, v186
  v_exp_f32 v187, v187
  v_exp_f32 v188, v188
  v_mfma_f32_16x16x32_bf16 v[44:47], v[40:43], v[28:31], v[44:47]
  v_exp_f32 v189, v189
  v_exp_f32 v190, v190
  v_exp_f32 v191, v191
  v_cvt_pk_bf16_f32 v36, v184, v185
  v_cvt_pk_bf16_f32 v37, v186, v187
  v_cvt_pk_bf16_f32 v38, v188, v189
  v_cvt_pk_bf16_f32 v39, v190, v191
  v_mfma_f32_32x32x16_bf16 v[176:191], v[68:71], v[16:19], v[144:159]
  ds_read_b32 v87, v3 offset:16
  v_exp_f32 v160, v160
  v_exp_f32 v161, v161
  v_exp_f32 v162, v162
  v_mfma_f32_32x32x16_bf16 v[176:191], v[72:75], v[20:23], v[176:191]
  v_exp_f32 v163, v163
  v_exp_f32 v164, v164
  v_exp_f32 v165, v165
  v_mfma_f32_32x32x16_bf16 v[112:127], v[76:79], v[32:35], v[112:127]
  v_exp_f32 v166, v166
  v_exp_f32 v167, v167
  v_exp_f32 v168, v168
  v_mfma_f32_16x16x32_bf16 v[48:51], v[40:43], v[32:35], v[48:51]
  v_cvt_pk_bf16_f32 v24, v160, v161
  v_cvt_pk_bf16_f32 v25, v162, v163
  v_cvt_pk_bf16_f32 v26, v164, v165
  v_cvt_pk_bf16_f32 v27, v166, v167
  v_mfma_f32_32x32x16_bf16 v[112:127], v[80:83], v[36:39], v[112:127]
  s_waitcnt lgkmcnt(0)
  v_exp_f32 v169, v169
  v_exp_f32 v170, v170
  v_exp_f32 v171, v171
  v_exp_f32 v172, v172
  v_mfma_f32_16x16x32_bf16 v[48:51], v[40:43], v[36:39], v[48:51]
  v_readfirstlane_b32 s32, v87
  v_exp_f32 v173, v173
  v_exp_f32 v174, v174
  v_exp_f32 v175, v175
  v_cvt_pk_bf16_f32 v28, v168, v169
  v_cvt_pk_bf16_f32 v29, v170, v171
  v_cvt_pk_bf16_f32 v30, v172, v173
  v_cvt_pk_bf16_f32 v31, v174, v175
  s_cmp_lt_u32 s32, s33
  s_cbranch_scc1 L_adaL_atC_slow14
L_adaL_atC_slowr14:
  v_mfma_f32_32x32x16_bf16 v[160:175], v[52:55], v[8:11], v[128:143]
  ds_read_b128 v[68:71], v84 offset:0
  v_exp_f32 v176, v176
  v_exp_f32 v177, v177
  v_exp_f32 v178, v178
  v_mfma_f32_32x32x16_bf16 v[160:175], v[56:59], v[12:15], v[160:175]
  ds_read_b128 v[72:75], v84 offset:1024
  v_exp_f32 v179, v179
  v_exp_f32 v180, v180
  v_exp_f32 v181, v181
  v_mfma_f32_32x32x16_bf16 v[96:111], v[60:63], v[24:27], v[96:111]
  ds_read_b128 v[76:79], v84 offset:63488
  v_exp_f32 v182, v182
  v_exp_f32 v183, v183
  v_exp_f32 v184, v184
  v_mfma_f32_16x16x32_bf16 v[44:47], v[40:43], v[24:27], v[44:47]
  v_cvt_pk_bf16_f32 v32, v176, v177
  v_cvt_pk_bf16_f32 v33, v178, v179
  v_cvt_pk_bf16_f32 v34, v180, v181
  v_cvt_pk_bf16_f32 v35, v182, v183
  v_mfma_f32_32x32x16_bf16 v[96:111], v[64:67], v[28:31], v[96:111]
  ds_read_b128 v[80:83], v84 offset:64512
  v_exp_f32 v185, v185
  v_exp_f32 v186, v186
  v_exp_f32 v187, v187
  v_exp_f32 v188, v188
  v_mfma_f32_16x16x32_bf16 v[44:47], v[40:43], v[28:31], v[44:47]
  s_add_u32 s33, s33, 1
  s_min_u32 s33, s33, 16
  v_exp_f32 v189, v189
  v_exp_f32 v190, v190
  v_exp_f32 v191, v191
  v_cvt_pk_bf16_f32 v36, v184, v185
  v_cvt_pk_bf16_f32 v37, v186, v187
  v_cvt_pk_bf16_f32 v38, v188, v189
  v_cvt_pk_bf16_f32 v39, v190, v191
  v_mfma_f32_32x32x16_bf16 v[176:191], v[52:55], v[16:19], v[144:159]
  v_exp_f32 v160, v160
  v_exp_f32 v161, v161
  v_exp_f32 v162, v162
  v_mfma_f32_32x32x16_bf16 v[176:191], v[56:59], v[20:23], v[176:191]
  v_exp_f32 v163, v163
  v_exp_f32 v164, v164
  v_exp_f32 v165, v165
  v_mfma_f32_32x32x16_bf16 v[112:127], v[60:63], v[32:35], v[112:127]
  v_exp_f32 v166, v166
  v_exp_f32 v167, v167
  v_exp_f32 v168, v168
  v_mfma_f32_16x16x32_bf16 v[48:51], v[40:43], v[32:35], v[48:51]
  v_cvt_pk_bf16_f32 v24, v160, v161
  v_cvt_pk_bf16_f32 v25, v162, v163
  v_cvt_pk_bf16_f32 v26, v164, v165
  v_cvt_pk_bf16_f32 v27, v166, v167
  v_mfma_f32_32x32x16_bf16 v[112:127], v[64:67], v[36:39], v[112:127]
  s_waitcnt lgkmcnt(0)
  v_exp_f32 v169, v169
  v_exp_f32 v170, v170
  v_exp_f32 v171, v171
  v_exp_f32 v172, v172
  v_mfma_f32_16x16x32_bf16 v[48:51], v[40:43], v[36:39], v[48:51]
  v_exp_f32 v173, v173
  v_exp_f32 v174, v174
  v_exp_f32 v175, v175
  v_cvt_pk_bf16_f32 v28, v168, v169
  v_cvt_pk_bf16_f32 v29, v170, v171
  v_cvt_pk_bf16_f32 v30, v172, v173
  v_cvt_pk_bf16_f32 v31, v174, v175
  v_mfma_f32_32x32x16_bf16 v[160:175], v[68:71], v[8:11], v[128:143]
  ds_read_b128 v[52:55], v84 offset:4096
  v_exp_f32 v176, v176
  v_exp_f32 v177, v177
  v_exp_f32 v178, v178
  v_mfma_f32_32x32x16_bf16 v[160:175], v[72:75], v[12:15], v[160:175]
  ds_read_b128 v[56:59], v84 offset:5120
  v_exp_f32 v179, v179
  v_exp_f32 v180, v180
  v_exp_f32 v181, v181
  v_mfma_f32_32x32x16_bf16 v[96:111], v[76:79], v[24:27], v[96:111]
  ds_read_b128 v[60:63], v84 offset:2048
  v_exp_f32 v182, v182
  v_exp_f32 v183, v183
  v_exp_f32 v184, v184
  v_mfma_f32_16x16x32_bf16 v[44:47], v[40:43], v[24:27], v[44:47]
  v_cvt_pk_bf16_f32 v32, v176, v177
  v_cvt_pk_bf16_f32 v33, v178, v179
  v_cvt_pk_bf16_f32 v34, v180, v181
  v_cvt_pk_bf16_f32 v35, v182, v183
  v_mfma_f32_32x32x16_bf16 v[96:111], v[80:83], v[28:31], v[96:111]
  ds_read_b128 v[64:67], v84 offset:3072
  v_exp_f32 v185, v185
  v_exp_f32 v186, v186
  v_exp_f32 v187, v187
  v_exp_f32 v188, v188
  v_mfma_f32_16x16x32_bf16 v[44:47], v[40:43], v[28:31], v[44:47]
  s_add_u32 s25, s25, 1
  v_exp_f32 v189, v189
  v_exp_f32 v190, v190
  v_exp_f32 v191, v191
  v_cvt_pk_bf16_f32 v36, v184, v185
  v_cvt_pk_bf16_f32 v37, v186, v187
  v_cvt_pk_bf16_f32 v38, v188, v189
  v_cvt_pk_bf16_f32 v39, v190, v191
  s_cmp_lt_u32 s25, 4
  s_cbranch_scc1 L_adaL_atC_loop
  v_mfma_f32_32x32x16_bf16 v[112:127], v[76:79], v[32:35], v[112:127]
  v_mfma_f32_16x16x32_bf16 v[48:51], v[40:43], v[32:35], v[48:51]
  v_mfma_f32_32x32x16_bf16 v[112:127], v[80:83], v[36:39], v[112:127]
  v_mfma_f32_16x16x32_bf16 v[48:51], v[40:43], v[36:39], v[48:51]
  v_mov_b32 v194, 0
  v_rcp_f32 v192, v44
  s_nop 0
  v_mul_f32 v96, v96, v192
  v_mul_f32 v97, v97, v192
  v_mul_f32 v98, v98, v192
  v_mul_f32 v99, v99, v192
  v_mul_f32 v100, v100, v192
  v_mul_f32 v101, v101, v192
  v_mul_f32 v102, v102, v192
  v_mul_f32 v103, v103, v192
  v_mul_f32 v104, v104, v192
  v_mul_f32 v105, v105, v192
  v_mul_f32 v106, v106, v192
  v_mul_f32 v107, v107, v192
  v_mul_f32 v108, v108, v192
  v_mul_f32 v109, v109, v192
  v_mul_f32 v110, v110, v192
  v_mul_f32 v111, v111, v192
  v_cvt_pk_bf16_f32 v196, v96, v97
  v_cvt_pk_bf16_f32 v197, v98, v99
  v_cvt_pk_bf16_f32 v198, v100, v101
  v_cvt_pk_bf16_f32 v199, v102, v103
  v_cvt_pk_bf16_f32 v200, v104, v105
  v_cvt_pk_bf16_f32 v201, v106, v107
  v_cvt_pk_bf16_f32 v202, v108, v109
  v_cvt_pk_bf16_f32 v203, v110, v111
  buffer_store_dwordx4 v[196:199], v2, s[8:11], s22 offen sc1
  buffer_store_dwordx4 v[200:203], v2, s[8:11], s22 offen offset:1024 sc1
  v_rcp_f32 v193, v48
  s_nop 0
  v_mul_f32 v112, v112, v193
  v_mul_f32 v113, v113, v193
  v_mul_f32 v114, v114, v193
  v_mul_f32 v115, v115, v193
  v_mul_f32 v116, v116, v193
  v_mul_f32 v117, v117, v193
  v_mul_f32 v118, v118, v193
  v_mul_f32 v119, v119, v193
  v_mul_f32 v120, v120, v193
  v_mul_f32 v121, v121, v193
  v_mul_f32 v122, v122, v193
  v_mul_f32 v123, v123, v193
  v_mul_f32 v124, v124, v193
  v_mul_f32 v125, v125, v193
  v_mul_f32 v126, v126, v193
  v_mul_f32 v127, v127, v193
  v_cvt_pk_bf16_f32 v204, v112, v113
  v_cvt_pk_bf16_f32 v205, v114, v115
  v_cvt_pk_bf16_f32 v206, v116, v117
  v_cvt_pk_bf16_f32 v207, v118, v119
  v_cvt_pk_bf16_f32 v208, v120, v121
  v_cvt_pk_bf16_f32 v209, v122, v123
  v_cvt_pk_bf16_f32 v210, v124, v125
  v_cvt_pk_bf16_f32 v211, v126, v127
  buffer_store_dwordx4 v[204:207], v2, s[8:11], s23 offen sc1
  buffer_store_dwordx4 v[208:211], v2, s[8:11], s23 offen offset:1024 sc1
  s_cmp_lg_u32 s24, 0
  s_cbranch_scc1 L_adaL_atC_fin2
  v_fmac_f32 v194, 0, v96
  v_fmac_f32 v194, 0, v97
  v_fmac_f32 v194, 0, v98
  v_fmac_f32 v194, 0, v99
  v_fmac_f32 v194, 0, v100
  v_fmac_f32 v194, 0, v101
  v_fmac_f32 v194, 0, v102
  v_fmac_f32 v194, 0, v103
  v_fmac_f32 v194, 0, v104
  v_fmac_f32 v194, 0, v105
  v_fmac_f32 v194, 0, v106
  v_fmac_f32 v194, 0, v107
  v_fmac_f32 v194, 0, v108
  v_fmac_f32 v194, 0, v109
  v_fmac_f32 v194, 0, v110
  v_fmac_f32 v194, 0, v111
  v_fmac_f32 v194, 0, v112
  v_fmac_f32 v194, 0, v113
  v_fmac_f32 v194, 0, v114
  v_fmac_f32 v194, 0, v115
  v_fmac_f32 v194, 0, v116
  v_fmac_f32 v194, 0, v117
  v_fmac_f32 v194, 0, v118
  v_fmac_f32 v194, 0, v119
  v_fmac_f32 v194, 0, v120
  v_fmac_f32 v194, 0, v121
  v_fmac_f32 v194, 0, v122
  v_fmac_f32 v194, 0, v123
  v_fmac_f32 v194, 0, v124
  v_fmac_f32 v194, 0, v125
  v_fmac_f32 v194, 0, v126
  v_fmac_f32 v194, 0, v127
  s_mov_b32 s26, 0x76800000
  v_cmp_ngt_f32 s[28:29], s26, v44
  v_cmp_ngt_f32 s[30:31], s26, v48
  v_cmp_u_f32 vcc, v194, v194
  s_nop 0
  s_or_b64 s[28:29], s[28:29], s[30:31]
  s_or_b64 s[28:29], s[28:29], vcc
  s_cselect_b32 s26, 1, 0
  v_mov_b32 v5, s26
  ds_write_b32 v85, v5 offset:32
  ds_write_b32 v85, v86
  s_waitcnt lgkmcnt(0)
  s_barrier
  ds_read_b128 v[4:7], v3 offset:32
  s_waitcnt lgkmcnt(0)
  v_or3_b32 v4, v4, v5, v6
  v_or_b32 v4, v4, v7
  s_nop 0
  v_readfirstlane_b32 s26, v4
  s_nop 0
  s_cmp_eq_u32 s26, 0
  s_cbranch_scc1 L_adaL_atC_fin
  v_mov_b32 v192, 0xff61b1e6
  v_mov_b32 v194, 0xff61b1e6
  s_mov_b32 s25, 0
  s_barrier
L_adaL_atC_mloop:
  s_and_b32 s26, s25, 3
  s_cmp_lg_u32 s26, 0
  s_cbranch_scc1 L_adaL_atC_mnobar
  s_lshr_b32 s33, s25, 2
  v_mov_b32 v86, s33
  ds_write_b32 v85, v86
  s_add_u32 s33, s33, 1
  s_mov_b32 s62, 0
L_adaL_atC_wm:
  ds_read_b32 v87, v3 offset:16
  s_add_u32 s62, s62, 1
  s_waitcnt lgkmcnt(0)
  s_cmp_gt_u32 s62, 0x1000000
  v_readfirstlane_b32 s63, v87
  s_cbranch_scc1 L_adaL_atC_wmx
  s_cmp_ge_u32 s63, s33
  s_cbranch_scc1 L_adaL_atC_wmx
  s_sleep 2
  s_branch L_adaL_atC_wm
L_adaL_atC_wmx:
L_adaL_atC_mnobar:
  s_and_b32 s26, s25, 15
  s_lshl_b32 s26, s26, 12
  v_add_u32 v4, s26, v84
  ds_read_b128 v[68:71], v4
  ds_read_b128 v[72:75], v4 offset:1024
  s_waitcnt lgkmcnt(0)
  v_mfma_f32_32x32x16_bf16 v[160:175], v[68:71], v[8:11], 0
  v_mfma_f32_32x32x16_bf16 v[160:175], v[72:75], v[12:15], v[160:175]
  v_mfma_f32_32x32x16_bf16 v[176:191], v[68:71], v[16:19], 0
  v_mfma_f32_32x32x16_bf16 v[176:191], v[72:75], v[20:23], v[176:191]
  s_nop 11
  v_max3_f32 v192, v192, v160, v161
  v_max3_f32 v192, v192, v162, v163
  v_max3_f32 v192, v192, v164, v165
  v_max3_f32 v192, v192, v166, v167
  v_max3_f32 v192, v192, v168, v169
  v_max3_f32 v192, v192, v170, v171
  v_max3_f32 v192, v192, v172, v173
  v_max3_f32 v192, v192, v174, v175
  v_max3_f32 v194, v194, v176, v177
  v_max3_f32 v194, v194, v178, v179
  v_max3_f32 v194, v194, v180, v181
  v_max3_f32 v194, v194, v182, v183
  v_max3_f32 v194, v194, v184, v185
  v_max3_f32 v194, v194, v186, v187
  v_max3_f32 v194, v194, v188, v189
  v_max3_f32 v194, v194, v190, v191
  s_add_u32 s25, s25, 1
  s_cmp_lt_u32 s25, 64
  s_cbranch_scc1 L_adaL_atC_mloop
  v_mov_b32 v193, v192
  v_mov_b32 v195, v194
  s_nop 1
  v_permlane32_swap_b32 v193, v192
  v_permlane32_swap_b32 v195, v194
  v_max_f32 v192, v192, v193
  v_sub_f32 v192, 0, v192
  v_max_f32 v194, v194, v195
  v_sub_f32 v194, 0, v194
  v_mov_b32 v128, v192
  v_mov_b32 v129, v192
  v_mov_b32 v130, v192
  v_mov_b32 v131, v192
  v_mov_b32 v132, v192
  v_mov_b32 v133, v192
  v_mov_b32 v134, v192
  v_mov_b32 v135, v192
  v_mov_b32 v136, v192
  v_mov_b32 v137, v192
  v_mov_b32 v138, v192
  v_mov_b32 v139, v192
  v_mov_b32 v140, v192
  v_mov_b32 v141, v192
  v_mov_b32 v142, v192
  v_mov_b32 v143, v192
  v_mov_b32 v144, v194
  v_mov_b32 v145, v194
  v_mov_b32 v146, v194
  v_mov_b32 v147, v194
  v_mov_b32 v148, v194
  v_mov_b32 v149, v194
  v_mov_b32 v150, v194
  v_mov_b32 v151, v194
  v_mov_b32 v152, v194
  v_mov_b32 v153, v194
  v_mov_b32 v154, v194
  v_mov_b32 v155, v194
  v_mov_b32 v156, v194
  v_mov_b32 v157, v194
  v_mov_b32 v158, v194
  v_mov_b32 v159, v194
  s_mov_b32 s24, 1
  s_barrier
  s_branch L_adaL_atC_main
L_adaL_atC_slow2:
  s_mov_b32 s62, 0
L_adaL_atC_sw2:
  ds_read_b32 v87, v3 offset:16
  s_add_u32 s62, s62, 1
  s_waitcnt lgkmcnt(0)
  s_cmp_gt_u32 s62, 0x1000000
  v_readfirstlane_b32 s63, v87
  s_cbranch_scc1 L_adaL_atC_sw2x
  s_cmp_ge_u32 s63, s33
  s_cbranch_scc1 L_adaL_atC_sw2x
  s_sleep 1
  s_branch L_adaL_atC_sw2
L_adaL_atC_sw2x:
  s_branch L_adaL_atC_slowr2
L_adaL_atC_slow6:
  s_mov_b32 s62, 0
L_adaL_atC_sw6:
  ds_read_b32 v87, v3 offset:16
  s_add_u32 s62, s62, 1
  s_waitcnt lgkmcnt(0)
  s_cmp_gt_u32 s62, 0x1000000
  v_readfirstlane_b32 s63, v87
  s_cbranch_scc1 L_adaL_atC_sw6x
  s_cmp_ge_u32 s63, s33
  s_cbranch_scc1 L_adaL_atC_sw6x
  s_sleep 1
  s_branch L_adaL_atC_sw6
L_adaL_atC_sw6x:
  s_branch L_adaL_atC_slowr6
L_adaL_atC_slow10:
  s_mov_b32 s62, 0
L_adaL_atC_sw10:
  ds_read_b32 v87, v3 offset:16
  s_add_u32 s62, s62, 1
  s_waitcnt lgkmcnt(0)
  s_cmp_gt_u32 s62, 0x1000000
  v_readfirstlane_b32 s63, v87
  s_cbranch_scc1 L_adaL_atC_sw10x
  s_cmp_ge_u32 s63, s33
  s_cbranch_scc1 L_adaL_atC_sw10x
  s_sleep 1
  s_branch L_adaL_atC_sw10
L_adaL_atC_sw10x:
  s_branch L_adaL_atC_slowr10
L_adaL_atC_slow14:
  s_mov_b32 s62, 0
L_adaL_atC_sw14:
  ds_read_b32 v87, v3 offset:16
  s_add_u32 s62, s62, 1
  s_waitcnt lgkmcnt(0)
  s_cmp_gt_u32 s62, 0x1000000
  v_readfirstlane_b32 s63, v87
  s_cbranch_scc1 L_adaL_atC_sw14x
  s_cmp_ge_u32 s63, s33
  s_cbranch_scc1 L_adaL_atC_sw14x
  s_sleep 1
  s_branch L_adaL_atC_sw14
L_adaL_atC_sw14x:
  s_branch L_adaL_atC_slowr14
L_adaL_atC_fin2:
  s_waitcnt lgkmcnt(0)
  s_barrier
L_adaL_atC_fin:
  v_mov_b32 v4, 0
  v_mov_b32 v5, 1
  s_mov_b64 exec, 1
  s_waitcnt vmcnt(0)
  buffer_atomic_add v5, v4, s[8:11], s40 offen sc1
  s_mov_b64 exec, -1
  s_and_b32 s16, s2, 7
  s_lshr_b32 s17, s2, 3
  s_and_b32 s18, s16, 1
  s_lshl_b32 s18, s18, 3
  s_and_b32 s19, s17, 7
  s_add_u32 s18, s18, s19
  s_lshr_b32 s19, s16, 1
  s_lshl_b32 s19, s19, 2
  s_lshr_b32 s17, s17, 3
  s_add_u32 s19, s19, s17
  s_bfe_u32 s20, s3, 0x10001
  s_and_b32 s21, s3, 1
  v_lshrrev_b32 v3, 4, v0
  v_and_b32 v4, 15, v0
  v_lshlrev_b32 v5, 9, v3
  v_lshl_add_u32 v5, v4, 4, v5
  s_mul_i32 s22, s20, 8192
  v_add_u32 v6, s22, v5
  s_mul_i32 s23, s21, 4096
  v_add_u32 v8, s23, v5
  v_mov_b32 v224, 0
  v_mov_b32 v225, 0
  v_mov_b32 v226, 0
  v_mov_b32 v227, 0
  v_mov_b32 v228, 0
  v_mov_b32 v229, 0
  v_mov_b32 v230, 0
  v_mov_b32 v231, 0
  v_mov_b32 v232, 0
  v_mov_b32 v233, 0
  v_mov_b32 v234, 0
  v_mov_b32 v235, 0
  v_mov_b32 v236, 0
  v_mov_b32 v237, 0
  v_mov_b32 v238, 0
  v_mov_b32 v239, 0
  v_mov_b32 v240, 0
  v_mov_b32 v241, 0
  v_mov_b32 v242, 0
  v_mov_b32 v243, 0
  v_mov_b32 v244, 0
  v_mov_b32 v245, 0
  v_mov_b32 v246, 0
  v_mov_b32 v247, 0
  v_mov_b32 v248, 0
  v_mov_b32 v249, 0
  v_mov_b32 v250, 0
  v_mov_b32 v251, 0
  v_mov_b32 v252, 0
  v_mov_b32 v253, 0
  v_mov_b32 v254, 0
  v_mov_b32 v255, 0
  s_mov_b32 s12, s64
  s_and_b32 s13, s65, 0xffff
  s_mov_b32 s14, 4194304
  s_mov_b32 s15, 0x20000
  s_lshl_b32 s26, s18, 2
  s_lshl_b32 s27, s20, 1
  s_add_u32 s26, s26, s27
  v_lshlrev_b32 v18, 11, v4
  v_lshl_add_u32 v18, v3, 4, v18
  v_lshlrev_b32 v19, 5, v3
  s_mov_b32 s23, 0
  s_mov_b32 s24, 0
  s_mov_b32 s59, 65536
  s_lshl_b32 s28, s19, 1
  s_add_u32 s28, s28, s21
  s_lshl_b32 s29, s26, 16
  s_lshl_b32 s30, s28, 6
  s_add_u32 s30, s30, s29
  s_mul_i32 s29, s26, 66560
  buffer_load_dwordx4 v[20:23], v18, s[12:15], s30 offen
  s_add_u32 s30, s30, 32768
  buffer_load_dwordx4 v[24:27], v18, s[12:15], s30 offen
  s_add_u32 s30, s30, 32768
  buffer_load_dwordx4 v[28:31], v18, s[12:15], s30 offen
  s_add_u32 s30, s30, 32768
  buffer_load_dwordx4 v[32:35], v18, s[12:15], s30 offen
  v_add_u32 v14, s23, v6
  v_add_u32 v16, s59, v8
  s_barrier
  ds_read_b128 v[128:131], v14 offset:0
  ds_read_b128 v[132:135], v14 offset:256
  ds_read_b128 v[136:139], v14 offset:4096
  ds_read_b128 v[140:143], v14 offset:4352
  ds_read_b128 v[144:147], v16 offset:0
  ds_read_b128 v[148:151], v16 offset:256
  ds_read_b128 v[152:155], v14 offset:2048
  ds_read_b128 v[156:159], v14 offset:2304
  ds_read_b128 v[160:163], v14 offset:6144
  ds_read_b128 v[164:167], v14 offset:6400
  ds_read_b128 v[168:171], v16 offset:2048
  ds_read_b128 v[172:175], v16 offset:2304
  s_add_u32 s23, s23, 16384
  s_cmp_eq_u32 s23, 65536
  s_cselect_b32 s23, 0, s23
  s_add_u32 s59, s59, 8192
  s_cmp_eq_u32 s59, 155648
  s_cselect_b32 s59, 65536, s59
  v_add_u32 v14, s23, v6
  v_add_u32 v16, s59, v8
  s_branch L_adaL_woC_cmid
L_adaL_woC_cloop:
  s_barrier
  v_mfma_f32_16x16x32_bf16 v[224:227], v[192:195], v[176:179], v[224:227]
  ds_read_b128 v[128:131], v14 offset:0
  ds_read_b128 v[132:135], v14 offset:256
  v_mfma_f32_16x16x32_bf16 v[232:235], v[192:195], v[180:183], v[232:235]
  ds_read_b128 v[136:139], v14 offset:4096
  ds_read_b128 v[140:143], v14 offset:4352
  v_mfma_f32_16x16x32_bf16 v[240:243], v[192:195], v[184:187], v[240:243]
  ds_read_b128 v[144:147], v16 offset:0
  ds_read_b128 v[148:151], v16 offset:256
  v_mfma_f32_16x16x32_bf16 v[248:251], v[192:195], v[188:191], v[248:251]
  ds_read_b128 v[152:155], v14 offset:2048
  ds_read_b128 v[156:159], v14 offset:2304
  v_mfma_f32_16x16x32_bf16 v[228:231], v[196:199], v[176:179], v[228:231]
  ds_read_b128 v[160:163], v14 offset:6144
  ds_read_b128 v[164:167], v14 offset:6400
  v_mfma_f32_16x16x32_bf16 v[236:239], v[196:199], v[180:183], v[236:239]
  ds_read_b128 v[168:171], v16 offset:2048
  ds_read_b128 v[172:175], v16 offset:2304
  v_mfma_f32_16x16x32_bf16 v[244:247], v[196:199], v[184:187], v[244:247]
  s_add_u32 s23, s23, 16384
  s_cmp_eq_u32 s23, 65536
  v_mfma_f32_16x16x32_bf16 v[252:255], v[196:199], v[188:191], v[252:255]
  s_cselect_b32 s23, 0, s23
  s_add_u32 s59, s59, 8192
  v_mfma_f32_16x16x32_bf16 v[224:227], v[216:219], v[200:203], v[224:227]
  s_cmp_eq_u32 s59, 155648
  s_cselect_b32 s59, 65536, s59
  v_mfma_f32_16x16x32_bf16 v[232:235], v[216:219], v[204:207], v[232:235]
  v_add_u32 v14, s23, v6
  v_add_u32 v16, s59, v8
  v_mfma_f32_16x16x32_bf16 v[240:243], v[216:219], v[208:211], v[240:243]
  v_mfma_f32_16x16x32_bf16 v[248:251], v[216:219], v[212:215], v[248:251]
  v_mfma_f32_16x16x32_bf16 v[228:231], v[220:223], v[200:203], v[228:231]
  v_mfma_f32_16x16x32_bf16 v[236:239], v[220:223], v[204:207], v[236:239]
  v_mfma_f32_16x16x32_bf16 v[244:247], v[220:223], v[208:211], v[244:247]
  v_mfma_f32_16x16x32_bf16 v[252:255], v[220:223], v[212:215], v[252:255]
L_adaL_woC_cmid:
  s_waitcnt lgkmcnt(0)
  s_barrier
  v_mfma_f32_16x16x32_bf16 v[224:227], v[144:147], v[128:131], v[224:227]
  ds_read_b128 v[176:179], v14 offset:0
  ds_read_b128 v[180:183], v14 offset:256
  v_mfma_f32_16x16x32_bf16 v[232:235], v[144:147], v[132:135], v[232:235]
  ds_read_b128 v[184:187], v14 offset:4096
  ds_read_b128 v[188:191], v14 offset:4352
  v_mfma_f32_16x16x32_bf16 v[240:243], v[144:147], v[136:139], v[240:243]
  ds_read_b128 v[192:195], v16 offset:0
  ds_read_b128 v[196:199], v16 offset:256
  v_mfma_f32_16x16x32_bf16 v[248:251], v[144:147], v[140:143], v[248:251]
  ds_read_b128 v[200:203], v14 offset:2048
  ds_read_b128 v[204:207], v14 offset:2304
  v_mfma_f32_16x16x32_bf16 v[228:231], v[148:151], v[128:131], v[228:231]
  ds_read_b128 v[208:211], v14 offset:6144
  ds_read_b128 v[212:215], v14 offset:6400
  v_mfma_f32_16x16x32_bf16 v[236:239], v[148:151], v[132:135], v[236:239]
  ds_read_b128 v[216:219], v16 offset:2048
  ds_read_b128 v[220:223], v16 offset:2304
  v_mfma_f32_16x16x32_bf16 v[244:247], v[148:151], v[136:139], v[244:247]
  s_add_u32 s23, s23, 16384
  s_cmp_eq_u32 s23, 65536
  v_mfma_f32_16x16x32_bf16 v[252:255], v[148:151], v[140:143], v[252:255]
  s_cselect_b32 s23, 0, s23
  s_add_u32 s59, s59, 8192
  v_mfma_f32_16x16x32_bf16 v[224:227], v[168:171], v[152:155], v[224:227]
  s_cmp_eq_u32 s59, 155648
  s_cselect_b32 s59, 65536, s59
  v_mfma_f32_16x16x32_bf16 v[232:235], v[168:171], v[156:159], v[232:235]
  v_add_u32 v14, s23, v6
  v_add_u32 v16, s59, v8
  v_mfma_f32_16x16x32_bf16 v[240:243], v[168:171], v[160:163], v[240:243]
  s_add_u32 s24, s24, 1
  v_mfma_f32_16x16x32_bf16 v[248:251], v[168:171], v[164:167], v[248:251]
  v_mfma_f32_16x16x32_bf16 v[228:231], v[172:175], v[152:155], v[228:231]
  v_mfma_f32_16x16x32_bf16 v[236:239], v[172:175], v[156:159], v[236:239]
  v_mfma_f32_16x16x32_bf16 v[244:247], v[172:175], v[160:163], v[244:247]
  v_mfma_f32_16x16x32_bf16 v[252:255], v[172:175], v[164:167], v[252:255]
  s_cmp_eq_u32 s24, 5
  s_cbranch_scc1 L_adaL_woC_hook
L_adaL_woC_hookr:
  s_cmp_lt_u32 s24, 8
  s_waitcnt lgkmcnt(0)
  s_cbranch_scc1 L_adaL_woC_cloop
  v_mfma_f32_16x16x32_bf16 v[224:227], v[192:195], v[176:179], v[224:227]
  v_mfma_f32_16x16x32_bf16 v[232:235], v[192:195], v[180:183], v[232:235]
  v_mfma_f32_16x16x32_bf16 v[240:243], v[192:195], v[184:187], v[240:243]
  v_mfma_f32_16x16x32_bf16 v[248:251], v[192:195], v[188:191], v[248:251]
  v_mfma_f32_16x16x32_bf16 v[228:231], v[196:199], v[176:179], v[228:231]
  v_mfma_f32_16x16x32_bf16 v[236:239], v[196:199], v[180:183], v[236:239]
  v_mfma_f32_16x16x32_bf16 v[244:247], v[196:199], v[184:187], v[244:247]
  v_mfma_f32_16x16x32_bf16 v[252:255], v[196:199], v[188:191], v[252:255]
  v_mfma_f32_16x16x32_bf16 v[224:227], v[216:219], v[200:203], v[224:227]
  v_mfma_f32_16x16x32_bf16 v[232:235], v[216:219], v[204:207], v[232:235]
  v_mfma_f32_16x16x32_bf16 v[240:243], v[216:219], v[208:211], v[240:243]
  v_mfma_f32_16x16x32_bf16 v[248:251], v[216:219], v[212:215], v[248:251]
  v_mfma_f32_16x16x32_bf16 v[228:231], v[220:223], v[200:203], v[228:231]
  v_mfma_f32_16x16x32_bf16 v[236:239], v[220:223], v[204:207], v[236:239]
  v_mfma_f32_16x16x32_bf16 v[244:247], v[220:223], v[208:211], v[244:247]
  v_mfma_f32_16x16x32_bf16 v[252:255], v[220:223], v[212:215], v[252:255]
  s_lshl_b32 s58, s18, 9
  s_lshr_b32 s42, s19, 2
  s_add_u32 s55, s58, 409664
  s_lshl_b32 s42, s42, 7
  s_add_u32 s58, s58, s42
  s_add_u32 s58, s58, 409600
  s_lshl_b32 s31, s28, 11
  s_add_u32 s31, s31, s29
  s_add_u32 s33, s31, 22282240
  s_add_u32 s35, s33, 66560
  s_waitcnt vmcnt(0)
  v_lshlrev_b32 v64, 16, v20
  v_and_b32 v65, 0xffff0000, v20
  v_lshlrev_b32 v66, 16, v21
  v_and_b32 v67, 0xffff0000, v21
  v_lshlrev_b32 v68, 16, v22
  v_and_b32 v69, 0xffff0000, v22
  v_lshlrev_b32 v70, 16, v23
  v_and_b32 v71, 0xffff0000, v23
  v_fmac_f32 v64, v224, v36
  v_fmac_f32 v65, v225, v37
  v_fmac_f32 v66, v226, v38
  v_fmac_f32 v67, v227, v39
  v_fmac_f32 v68, v228, v40
  v_fmac_f32 v69, v229, v41
  v_fmac_f32 v70, v230, v42
  v_fmac_f32 v71, v231, v43
  v_mul_f32 v224, v64, v44
  v_mul_f32 v225, v65, v45
  v_mul_f32 v226, v66, v46
  v_mul_f32 v227, v67, v47
  v_mul_f32 v228, v68, v48
  v_mul_f32 v229, v69, v49
  v_mul_f32 v230, v70, v50
  v_mul_f32 v231, v71, v51
  v_cvt_pk_bf16_f32 v224, v224, v225
  v_cvt_pk_bf16_f32 v225, v226, v227
  v_cvt_pk_bf16_f32 v226, v228, v229
  v_cvt_pk_bf16_f32 v227, v230, v231
  buffer_store_dwordx4 v[224:227], v5, s[8:11], s33 offen offset:0 sc1
  v_lshlrev_b32 v72, 16, v24
  v_and_b32 v73, 0xffff0000, v24
  v_lshlrev_b32 v74, 16, v25
  v_and_b32 v75, 0xffff0000, v25
  v_lshlrev_b32 v76, 16, v26
  v_and_b32 v77, 0xffff0000, v26
  v_lshlrev_b32 v78, 16, v27
  v_and_b32 v79, 0xffff0000, v27
  v_fmac_f32 v72, v232, v36
  v_fmac_f32 v73, v233, v37
  v_fmac_f32 v74, v234, v38
  v_fmac_f32 v75, v235, v39
  v_fmac_f32 v76, v236, v40
  v_fmac_f32 v77, v237, v41
  v_fmac_f32 v78, v238, v42
  v_fmac_f32 v79, v239, v43
  v_mul_f32 v232, v72, v44
  v_mul_f32 v233, v73, v45
  v_mul_f32 v234, v74, v46
  v_mul_f32 v235, v75, v47
  v_mul_f32 v236, v76, v48
  v_mul_f32 v237, v77, v49
  v_mul_f32 v238, v78, v50
  v_mul_f32 v239, v79, v51
  v_cvt_pk_bf16_f32 v232, v232, v233
  v_cvt_pk_bf16_f32 v233, v234, v235
  v_cvt_pk_bf16_f32 v234, v236, v237
  v_cvt_pk_bf16_f32 v235, v238, v239
  buffer_store_dwordx4 v[232:235], v5, s[8:11], s33 offen offset:256 sc1
  v_lshlrev_b32 v80, 16, v28
  v_and_b32 v81, 0xffff0000, v28
  v_lshlrev_b32 v82, 16, v29
  v_and_b32 v83, 0xffff0000, v29
  v_lshlrev_b32 v84, 16, v30
  v_and_b32 v85, 0xffff0000, v30
  v_lshlrev_b32 v86, 16, v31
  v_and_b32 v87, 0xffff0000, v31
  v_fmac_f32 v80, v240, v36
  v_fmac_f32 v81, v241, v37
  v_fmac_f32 v82, v242, v38
  v_fmac_f32 v83, v243, v39
  v_fmac_f32 v84, v244, v40
  v_fmac_f32 v85, v245, v41
  v_fmac_f32 v86, v246, v42
  v_fmac_f32 v87, v247, v43
  v_mul_f32 v240, v80, v44
  v_mul_f32 v241, v81, v45
  v_mul_f32 v242, v82, v46
  v_mul_f32 v243, v83, v47
  v_mul_f32 v244, v84, v48
  v_mul_f32 v245, v85, v49
  v_mul_f32 v246, v86, v50
  v_mul_f32 v247, v87, v51
  v_cvt_pk_bf16_f32 v240, v240, v241
  v_cvt_pk_bf16_f32 v241, v242, v243
  v_cvt_pk_bf16_f32 v242, v244, v245
  v_cvt_pk_bf16_f32 v243, v246, v247
  buffer_store_dwordx4 v[240:243], v5, s[8:11], s35 offen offset:0 sc1
  v_lshlrev_b32 v88, 16, v32
  v_and_b32 v89, 0xffff0000, v32
  v_lshlrev_b32 v90, 16, v33
  v_and_b32 v91, 0xffff0000, v33
  v_lshlrev_b32 v92, 16, v34
  v_and_b32 v93, 0xffff0000, v34
  v_lshlrev_b32 v94, 16, v35
  v_and_b32 v95, 0xffff0000, v35
  v_fmac_f32 v88, v248, v36
  v_fmac_f32 v89, v249, v37
  v_fmac_f32 v90, v250, v38
  v_fmac_f32 v91, v251, v39
  v_fmac_f32 v92, v252, v40
  v_fmac_f32 v93, v253, v41
  v_fmac_f32 v94, v254, v42
  v_fmac_f32 v95, v255, v43
  v_mul_f32 v248, v88, v44
  v_mul_f32 v249, v89, v45
  v_mul_f32 v250, v90, v46
  v_mul_f32 v251, v91, v47
  v_mul_f32 v252, v92, v48
  v_mul_f32 v253, v93, v49
  v_mul_f32 v254, v94, v50
  v_mul_f32 v255, v95, v51
  v_cvt_pk_bf16_f32 v248, v248, v249
  v_cvt_pk_bf16_f32 v249, v250, v251
  v_cvt_pk_bf16_f32 v250, v252, v253
  v_cvt_pk_bf16_f32 v251, v254, v255
  buffer_store_dwordx4 v[248:251], v5, s[8:11], s35 offen offset:256 sc1
  v_cvt_pk_bf16_f32 v20, v64, v65
  v_cvt_pk_bf16_f32 v21, v66, v67
  v_cvt_pk_bf16_f32 v22, v68, v69
  v_cvt_pk_bf16_f32 v23, v70, v71
  v_cvt_pk_bf16_f32 v24, v72, v73
  v_cvt_pk_bf16_f32 v25, v74, v75
  v_cvt_pk_bf16_f32 v26, v76, v77
  v_cvt_pk_bf16_f32 v27, v78, v79
  v_cvt_pk_bf16_f32 v28, v80, v81
  v_cvt_pk_bf16_f32 v29, v82, v83
  v_cvt_pk_bf16_f32 v30, v84, v85
  v_cvt_pk_bf16_f32 v31, v86, v87
  v_cvt_pk_bf16_f32 v32, v88, v89
  v_cvt_pk_bf16_f32 v33, v90, v91
  v_cvt_pk_bf16_f32 v34, v92, v93
  v_cvt_pk_bf16_f32 v35, v94, v95
  v_add_f32 v96, v64, v65
  v_mul_f32 v100, v64, v64
  v_add_f32 v97, v72, v73
  v_mul_f32 v101, v72, v72
  v_add_f32 v98, v80, v81
  v_mul_f32 v102, v80, v80
  v_add_f32 v99, v88, v89
  v_mul_f32 v103, v88, v88
  v_fmac_f32 v100, v65, v65
  v_fmac_f32 v101, v73, v73
  v_fmac_f32 v102, v81, v81
  v_fmac_f32 v103, v89, v89
  v_add_f32 v96, v96, v66
  v_fmac_f32 v100, v66, v66
  v_add_f32 v97, v97, v74
  v_fmac_f32 v101, v74, v74
  v_add_f32 v98, v98, v82
  v_fmac_f32 v102, v82, v82
  v_add_f32 v99, v99, v90
  v_fmac_f32 v103, v90, v90
  v_add_f32 v96, v96, v67
  v_fmac_f32 v100, v67, v67
  v_add_f32 v97, v97, v75
  v_fmac_f32 v101, v75, v75
  v_add_f32 v98, v98, v83
  v_fmac_f32 v102, v83, v83
  v_add_f32 v99, v99, v91
  v_fmac_f32 v103, v91, v91
  v_add_f32 v96, v96, v68
  v_fmac_f32 v100, v68, v68
  v_add_f32 v97, v97, v76
  v_fmac_f32 v101, v76, v76
  v_add_f32 v98, v98, v84
  v_fmac_f32 v102, v84, v84
  v_add_f32 v99, v99, v92
  v_fmac_f32 v103, v92, v92
  v_add_f32 v96, v96, v69
  v_fmac_f32 v100, v69, v69
  v_add_f32 v97, v97, v77
  v_fmac_f32 v101, v77, v77
  v_add_f32 v98, v98, v85
  v_fmac_f32 v102, v85, v85
  v_add_f32 v99, v99, v93
  v_fmac_f32 v103, v93, v93
  v_add_f32 v96, v96, v70
  v_fmac_f32 v100, v70, v70
  v_add_f32 v97, v97, v78
  v_fmac_f32 v101, v78, v78
  v_add_f32 v98, v98, v86
  v_fmac_f32 v102, v86, v86
  v_add_f32 v99, v99, v94
  v_fmac_f32 v103, v94, v94
  v_add_f32 v96, v96, v71
  v_fmac_f32 v100, v71, v71
  v_add_f32 v97, v97, v79
  v_fmac_f32 v101, v79, v79
  v_add_f32 v98, v98, v87
  v_fmac_f32 v102, v87, v87
  v_add_f32 v99, v99, v95
  v_fmac_f32 v103, v95, v95
  s_nop 1
  v_permlane32_swap_b32 v96, v98
  v_permlane32_swap_b32 v97, v99
  v_permlane32_swap_b32 v100, v102
  v_permlane32_swap_b32 v101, v103
  v_add_f32 v96, v96, v98
  v_add_f32 v97, v97, v99
  v_add_f32 v100, v100, v102
  v_add_f32 v101, v101, v103
  s_nop 1
  v_permlane16_swap_b32 v96, v97
  v_permlane16_swap_b32 v100, v101
  v_add_f32 v104, v96, v97
  v_add_f32 v105, v100, v101
  s_lshl_b32 s31, s26, 4
  s_add_u32 s31, s31, s28
  s_lshl_b32 s31, s31, 9
  s_add_u32 s31, s31, 524288
  v_lshlrev_b32 v18, 3, v0
  buffer_store_dwordx2 v[104:105], v18, s[8:11], s31 offen sc1
  v_mov_b32 v12, 0
  v_mov_b32 v13, 1
  s_mov_b64 exec, 1
  s_waitcnt vmcnt(1)
  buffer_atomic_add v13, v12, s[8:11], s58 offen sc1
  s_mov_b64 exec, -1
  s_barrier
  s_and_b32 s16, s2, 7
  s_lshr_b32 s17, s2, 3
  s_and_b32 s18, s16, 1
  s_lshl_b32 s18, s18, 3
  s_and_b32 s19, s17, 7
  s_add_u32 s18, s18, s19
  s_lshr_b32 s19, s16, 1
  s_lshl_b32 s19, s19, 2
  s_lshr_b32 s17, s17, 3
  s_add_u32 s19, s19, s17
  s_bfe_u32 s20, s3, 0x10001
  s_and_b32 s21, s3, 1
  v_lshrrev_b32 v3, 4, v0
  v_and_b32 v4, 15, v0
  v_lshlrev_b32 v5, 9, v3
  v_lshl_add_u32 v5, v4, 4, v5
  s_mul_i32 s22, s20, 4096
  v_add_u32 v6, s22, v5
  s_mul_i32 s23, s21, 8192
  v_add_u32 v8, s23, v5
  s_lshl_b32 s23, s21, 8
  v_add_u32 v9, s23, v5
  v_mov_b32 v144, 0
  v_mov_b32 v145, 0
  v_mov_b32 v146, 0
  v_mov_b32 v147, 0
  v_mov_b32 v148, 0
  v_mov_b32 v149, 0
  v_mov_b32 v150, 0
  v_mov_b32 v151, 0
  v_mov_b32 v152, 0
  v_mov_b32 v153, 0
  v_mov_b32 v154, 0
  v_mov_b32 v155, 0
  v_mov_b32 v156, 0
  v_mov_b32 v157, 0
  v_mov_b32 v158, 0
  v_mov_b32 v159, 0
  v_mov_b32 v160, 0
  v_mov_b32 v161, 0
  v_mov_b32 v162, 0
  v_mov_b32 v163, 0
  v_mov_b32 v164, 0
  v_mov_b32 v165, 0
  v_mov_b32 v166, 0
  v_mov_b32 v167, 0
  v_mov_b32 v168, 0
  v_mov_b32 v169, 0
  v_mov_b32 v170, 0
  v_mov_b32 v171, 0
  v_mov_b32 v172, 0
  v_mov_b32 v173, 0
  v_mov_b32 v174, 0
  v_mov_b32 v175, 0
  v_mov_b32 v176, 0
  v_mov_b32 v177, 0
  v_mov_b32 v178, 0
  v_mov_b32 v179, 0
  v_mov_b32 v180, 0
  v_mov_b32 v181, 0
  v_mov_b32 v182, 0
  v_mov_b32 v183, 0
  v_mov_b32 v184, 0
  v_mov_b32 v185, 0
  v_mov_b32 v186, 0
  v_mov_b32 v187, 0
  v_mov_b32 v188, 0
  v_mov_b32 v189, 0
  v_mov_b32 v190, 0
  v_mov_b32 v191, 0
  v_mov_b32 v192, 0
  v_mov_b32 v193, 0
  v_mov_b32 v194, 0
  v_mov_b32 v195, 0
  v_mov_b32 v196, 0
  v_mov_b32 v197, 0
  v_mov_b32 v198, 0
  v_mov_b32 v199, 0
  v_mov_b32 v200, 0
  v_mov_b32 v201, 0
  v_mov_b32 v202, 0
  v_mov_b32 v203, 0
  v_mov_b32 v204, 0
  v_mov_b32 v205, 0
  v_mov_b32 v206, 0
  v_mov_b32 v207, 0
  v_mov_b32 v208, 0
  v_mov_b32 v209, 0
  v_mov_b32 v210, 0
  v_mov_b32 v211, 0
  v_mov_b32 v212, 0
  v_mov_b32 v213, 0
  v_mov_b32 v214, 0
  v_mov_b32 v215, 0
  v_mov_b32 v216, 0
  v_mov_b32 v217, 0
  v_mov_b32 v218, 0
  v_mov_b32 v219, 0
  v_mov_b32 v220, 0
  v_mov_b32 v221, 0
  v_mov_b32 v222, 0
  v_mov_b32 v223, 0
  v_mov_b32 v224, 0
  v_mov_b32 v225, 0
  v_mov_b32 v226, 0
  v_mov_b32 v227, 0
  v_mov_b32 v228, 0
  v_mov_b32 v229, 0
  v_mov_b32 v230, 0
  v_mov_b32 v231, 0
  v_mov_b32 v232, 0
  v_mov_b32 v233, 0
  v_mov_b32 v234, 0
  v_mov_b32 v235, 0
  v_mov_b32 v236, 0
  v_mov_b32 v237, 0
  v_mov_b32 v238, 0
  v_mov_b32 v239, 0
  v_mov_b32 v240, 0
  v_mov_b32 v241, 0
  v_mov_b32 v242, 0
  v_mov_b32 v243, 0
  v_mov_b32 v244, 0
  v_mov_b32 v245, 0
  v_mov_b32 v246, 0
  v_mov_b32 v247, 0
  v_mov_b32 v248, 0
  v_mov_b32 v249, 0
  v_mov_b32 v250, 0
  v_mov_b32 v251, 0
  v_mov_b32 v252, 0
  v_mov_b32 v253, 0
  v_mov_b32 v254, 0
  v_mov_b32 v255, 0
  s_lshl_b32 s26, s18, 2
  s_lshl_b32 s27, s20, 1
  s_add_u32 s26, s26, s27
  s_mov_b32 s23, 0
  s_mov_b32 s24, 0
  s_mov_b32 s59, 32768
  v_add_u32 v14, s23, v6
  v_add_u32 v16, s59, v8
  v_add_u32 v17, s59, v9
  s_barrier
  ds_read_b128 v[56:59], v14 offset:0
  ds_read_b128 v[60:63], v14 offset:256
  ds_read_b128 v[64:67], v14 offset:2048
  ds_read_b128 v[68:71], v14 offset:2304
  ds_read_b128 v[72:75], v16 offset:0
  ds_read_b128 v[76:79], v16 offset:256
  ds_read_b128 v[80:83], v16 offset:2048
  ds_read_b128 v[84:87], v16 offset:2304
  ds_read_b128 v[88:91], v16 offset:4096
  ds_read_b128 v[92:95], v16 offset:4352
  ds_read_b128 v[96:99], v17 offset:6144
  s_add_u32 s23, s23, 8192
  s_cmp_eq_u32 s23, 32768
  s_cselect_b32 s23, 0, s23
  s_add_u32 s59, s59, 14336
  s_cmp_eq_u32 s59, 161792
  s_cselect_b32 s59, 32768, s59
  v_add_u32 v14, s23, v6
  v_add_u32 v16, s59, v8
  v_add_u32 v17, s59, v9
  s_branch L_adaL_ffn1C_cmid
L_adaL_ffn1C_cloop:
  s_barrier
  v_mfma_f32_16x16x32_bf16 v[144:147], v[116:119], v[100:103], v[144:147]
  ds_read_b128 v[56:59], v14 offset:0
  v_mfma_f32_16x16x32_bf16 v[172:175], v[116:119], v[104:107], v[172:175]
  ds_read_b128 v[60:63], v14 offset:256
  v_mfma_f32_16x16x32_bf16 v[200:203], v[116:119], v[108:111], v[200:203]
  ds_read_b128 v[64:67], v14 offset:2048
  v_mfma_f32_16x16x32_bf16 v[228:231], v[116:119], v[112:115], v[228:231]
  ds_read_b128 v[68:71], v14 offset:2304
  v_mfma_f32_16x16x32_bf16 v[148:151], v[120:123], v[100:103], v[148:151]
  ds_read_b128 v[72:75], v16 offset:0
  v_mfma_f32_16x16x32_bf16 v[176:179], v[120:123], v[104:107], v[176:179]
  ds_read_b128 v[76:79], v16 offset:256
  v_mfma_f32_16x16x32_bf16 v[204:207], v[120:123], v[108:111], v[204:207]
  ds_read_b128 v[80:83], v16 offset:2048
  v_mfma_f32_16x16x32_bf16 v[232:235], v[120:123], v[112:115], v[232:235]
  ds_read_b128 v[84:87], v16 offset:2304
  v_mfma_f32_16x16x32_bf16 v[152:155], v[124:127], v[100:103], v[152:155]
  ds_read_b128 v[88:91], v16 offset:4096
  v_mfma_f32_16x16x32_bf16 v[180:183], v[124:127], v[104:107], v[180:183]
  ds_read_b128 v[92:95], v16 offset:4352
  v_mfma_f32_16x16x32_bf16 v[208:211], v[124:127], v[108:111], v[208:211]
  ds_read_b128 v[96:99], v17 offset:6144
  v_mfma_f32_16x16x32_bf16 v[236:239], v[124:127], v[112:115], v[236:239]
  s_add_u32 s23, s23, 8192
  v_mfma_f32_16x16x32_bf16 v[156:159], v[128:131], v[100:103], v[156:159]
  s_cmp_eq_u32 s23, 32768
  v_mfma_f32_16x16x32_bf16 v[184:187], v[128:131], v[104:107], v[184:187]
  s_cselect_b32 s23, 0, s23
  v_mfma_f32_16x16x32_bf16 v[212:215], v[128:131], v[108:111], v[212:215]
  s_add_u32 s59, s59, 14336
  v_mfma_f32_16x16x32_bf16 v[240:243], v[128:131], v[112:115], v[240:243]
  s_cmp_eq_u32 s59, 161792
  v_mfma_f32_16x16x32_bf16 v[160:163], v[132:135], v[100:103], v[160:163]
  s_cselect_b32 s59, 32768, s59
  v_mfma_f32_16x16x32_bf16 v[188:191], v[132:135], v[104:107], v[188:191]
  v_add_u32 v14, s23, v6
  v_mfma_f32_16x16x32_bf16 v[216:219], v[132:135], v[108:111], v[216:219]
  v_add_u32 v16, s59, v8
  v_mfma_f32_16x16x32_bf16 v[244:247], v[132:135], v[112:115], v[244:247]
  v_add_u32 v17, s59, v9
  v_mfma_f32_16x16x32_bf16 v[164:167], v[136:139], v[100:103], v[164:167]
  v_mfma_f32_16x16x32_bf16 v[192:195], v[136:139], v[104:107], v[192:195]
  v_mfma_f32_16x16x32_bf16 v[220:223], v[136:139], v[108:111], v[220:223]
  v_mfma_f32_16x16x32_bf16 v[248:251], v[136:139], v[112:115], v[248:251]
  v_mfma_f32_16x16x32_bf16 v[168:171], v[140:143], v[100:103], v[168:171]
  v_mfma_f32_16x16x32_bf16 v[196:199], v[140:143], v[104:107], v[196:199]
  v_mfma_f32_16x16x32_bf16 v[224:227], v[140:143], v[108:111], v[224:227]
  v_mfma_f32_16x16x32_bf16 v[252:255], v[140:143], v[112:115], v[252:255]
L_adaL_ffn1C_cmid:
  s_waitcnt lgkmcnt(0)
  s_barrier
  v_mfma_f32_16x16x32_bf16 v[144:147], v[72:75], v[56:59], v[144:147]
  ds_read_b128 v[100:103], v14 offset:0
  v_mfma_f32_16x16x32_bf16 v[172:175], v[72:75], v[60:63], v[172:175]
  ds_read_b128 v[104:107], v14 offset:256
  v_mfma_f32_16x16x32_bf16 v[200:203], v[72:75], v[64:67], v[200:203]
  ds_read_b128 v[108:111], v14 offset:2048
  v_mfma_f32_16x16x32_bf16 v[228:231], v[72:75], v[68:71], v[228:231]
  ds_read_b128 v[112:115], v14 offset:2304
  v_mfma_f32_16x16x32_bf16 v[148:151], v[76:79], v[56:59], v[148:151]
  ds_read_b128 v[116:119], v16 offset:0
  v_mfma_f32_16x16x32_bf16 v[176:179], v[76:79], v[60:63], v[176:179]
  ds_read_b128 v[120:123], v16 offset:256
  v_mfma_f32_16x16x32_bf16 v[204:207], v[76:79], v[64:67], v[204:207]
  ds_read_b128 v[124:127], v16 offset:2048
  v_mfma_f32_16x16x32_bf16 v[232:235], v[76:79], v[68:71], v[232:235]
  ds_read_b128 v[128:131], v16 offset:2304
  v_mfma_f32_16x16x32_bf16 v[152:155], v[80:83], v[56:59], v[152:155]
  ds_read_b128 v[132:135], v16 offset:4096
  v_mfma_f32_16x16x32_bf16 v[180:183], v[80:83], v[60:63], v[180:183]
  ds_read_b128 v[136:139], v16 offset:4352
  v_mfma_f32_16x16x32_bf16 v[208:211], v[80:83], v[64:67], v[208:211]
  ds_read_b128 v[140:143], v17 offset:6144
  v_mfma_f32_16x16x32_bf16 v[236:239], v[80:83], v[68:71], v[236:239]
  s_add_u32 s23, s23, 8192
  v_mfma_f32_16x16x32_bf16 v[156:159], v[84:87], v[56:59], v[156:159]
  s_cmp_eq_u32 s23, 32768
  v_mfma_f32_16x16x32_bf16 v[184:187], v[84:87], v[60:63], v[184:187]
  s_cselect_b32 s23, 0, s23
  v_mfma_f32_16x16x32_bf16 v[212:215], v[84:87], v[64:67], v[212:215]
  s_add_u32 s59, s59, 14336
  v_mfma_f32_16x16x32_bf16 v[240:243], v[84:87], v[68:71], v[240:243]
  s_cmp_eq_u32 s59, 161792
  v_mfma_f32_16x16x32_bf16 v[160:163], v[88:91], v[56:59], v[160:163]
  s_cselect_b32 s59, 32768, s59
  v_mfma_f32_16x16x32_bf16 v[188:191], v[88:91], v[60:63], v[188:191]
  v_add_u32 v14, s23, v6
  v_mfma_f32_16x16x32_bf16 v[216:219], v[88:91], v[64:67], v[216:219]
  v_add_u32 v16, s59, v8
  v_mfma_f32_16x16x32_bf16 v[244:247], v[88:91], v[68:71], v[244:247]
  v_add_u32 v17, s59, v9
  v_mfma_f32_16x16x32_bf16 v[164:167], v[92:95], v[56:59], v[164:167]
  s_add_u32 s24, s24, 1
  v_mfma_f32_16x16x32_bf16 v[192:195], v[92:95], v[60:63], v[192:195]
  v_mfma_f32_16x16x32_bf16 v[220:223], v[92:95], v[64:67], v[220:223]
  v_mfma_f32_16x16x32_bf16 v[248:251], v[92:95], v[68:71], v[248:251]
  v_mfma_f32_16x16x32_bf16 v[168:171], v[96:99], v[56:59], v[168:171]
  v_mfma_f32_16x16x32_bf16 v[196:199], v[96:99], v[60:63], v[196:199]
  v_mfma_f32_16x16x32_bf16 v[224:227], v[96:99], v[64:67], v[224:227]
  v_mfma_f32_16x16x32_bf16 v[252:255], v[96:99], v[68:71], v[252:255]
  s_cmp_eq_u32 s24, 1
  s_cbranch_scc1 L_adaL_ffn1C_hook
L_adaL_ffn1C_hookr:
  s_cmp_lt_u32 s24, 16
  s_waitcnt lgkmcnt(0)
  s_cbranch_scc1 L_adaL_ffn1C_cloop
  s_lshl_b32 s22, s20, 12
  s_add_u32 s22, s22, 0
  v_add_u32 v14, s22, v5
  v_and_b32 v16, 0x3ff, v5
  s_lshl_b32 s22, s21, 8
  s_add_u32 s22, s22, 107520
  v_add_u32 v17, s22, v16
  s_lshl_b32 s22, s21, 12
  s_add_u32 s22, s22, 104448
  v_add_u32 v16, s22, v16
  s_barrier
  v_mfma_f32_16x16x32_bf16 v[144:147], v[116:119], v[100:103], v[144:147]
  ds_read_b128 v[56:59], v14 offset:0
  v_mfma_f32_16x16x32_bf16 v[172:175], v[116:119], v[104:107], v[172:175]
  ds_read_b128 v[60:63], v14 offset:256
  v_mfma_f32_16x16x32_bf16 v[200:203], v[116:119], v[108:111], v[200:203]
  ds_read_b128 v[64:67], v14 offset:2048
  v_mfma_f32_16x16x32_bf16 v[228:231], v[116:119], v[112:115], v[228:231]
  ds_read_b128 v[68:71], v14 offset:2304
  v_mfma_f32_16x16x32_bf16 v[148:151], v[120:123], v[100:103], v[148:151]
  ds_read_b128 v[72:75], v16 offset:0
  v_mfma_f32_16x16x32_bf16 v[176:179], v[120:123], v[104:107], v[176:179]
  ds_read_b128 v[76:79], v16 offset:256
  v_mfma_f32_16x16x32_bf16 v[204:207], v[120:123], v[108:111], v[204:207]
  ds_read_b128 v[80:83], v16 offset:1024
  v_mfma_f32_16x16x32_bf16 v[232:235], v[120:123], v[112:115], v[232:235]
  ds_read_b128 v[84:87], v16 offset:1280
  v_mfma_f32_16x16x32_bf16 v[152:155], v[124:127], v[100:103], v[152:155]
  ds_read_b128 v[88:91], v16 offset:2048
  v_mfma_f32_16x16x32_bf16 v[180:183], v[124:127], v[104:107], v[180:183]
  ds_read_b128 v[92:95], v16 offset:2304
  v_mfma_f32_16x16x32_bf16 v[208:211], v[124:127], v[108:111], v[208:211]
  ds_read_b128 v[96:99], v17
  v_mfma_f32_16x16x32_bf16 v[236:239], v[124:127], v[112:115], v[236:239]
  v_mfma_f32_16x16x32_bf16 v[156:159], v[128:131], v[100:103], v[156:159]
  v_mfma_f32_16x16x32_bf16 v[184:187], v[128:131], v[104:107], v[184:187]
  v_mfma_f32_16x16x32_bf16 v[212:215], v[128:131], v[108:111], v[212:215]
  v_mfma_f32_16x16x32_bf16 v[240:243], v[128:131], v[112:115], v[240:243]
  v_mfma_f32_16x16x32_bf16 v[160:163], v[132:135], v[100:103], v[160:163]
  v_mfma_f32_16x16x32_bf16 v[188:191], v[132:135], v[104:107], v[188:191]
  v_mfma_f32_16x16x32_bf16 v[216:219], v[132:135], v[108:111], v[216:219]
  v_mfma_f32_16x16x32_bf16 v[244:247], v[132:135], v[112:115], v[244:247]
  v_mfma_f32_16x16x32_bf16 v[164:167], v[136:139], v[100:103], v[164:167]
  v_mfma_f32_16x16x32_bf16 v[192:195], v[136:139], v[104:107], v[192:195]
  v_mfma_f32_16x16x32_bf16 v[220:223], v[136:139], v[108:111], v[220:223]
  v_mfma_f32_16x16x32_bf16 v[248:251], v[136:139], v[112:115], v[248:251]
  v_mfma_f32_16x16x32_bf16 v[168:171], v[140:143], v[100:103], v[168:171]
  v_mfma_f32_16x16x32_bf16 v[196:199], v[140:143], v[104:107], v[196:199]
  v_mfma_f32_16x16x32_bf16 v[224:227], v[140:143], v[108:111], v[224:227]
  v_mfma_f32_16x16x32_bf16 v[252:255], v[140:143], v[112:115], v[252:255]
  s_waitcnt lgkmcnt(0)
  v_mfma_f32_16x16x32_bf16 v[144:147], v[72:75], v[56:59], v[144:147]
  v_mfma_f32_16x16x32_bf16 v[172:175], v[72:75], v[60:63], v[172:175]
  v_mfma_f32_16x16x32_bf16 v[200:203], v[72:75], v[64:67], v[200:203]
  v_mfma_f32_16x16x32_bf16 v[228:231], v[72:75], v[68:71], v[228:231]
  v_mfma_f32_16x16x32_bf16 v[148:151], v[76:79], v[56:59], v[148:151]
  v_mfma_f32_16x16x32_bf16 v[176:179], v[76:79], v[60:63], v[176:179]
  v_mfma_f32_16x16x32_bf16 v[204:207], v[76:79], v[64:67], v[204:207]
  v_mfma_f32_16x16x32_bf16 v[232:235], v[76:79], v[68:71], v[232:235]
  v_mfma_f32_16x16x32_bf16 v[152:155], v[80:83], v[56:59], v[152:155]
  v_mfma_f32_16x16x32_bf16 v[180:183], v[80:83], v[60:63], v[180:183]
  v_mfma_f32_16x16x32_bf16 v[208:211], v[80:83], v[64:67], v[208:211]
  v_mfma_f32_16x16x32_bf16 v[236:239], v[80:83], v[68:71], v[236:239]
  v_mfma_f32_16x16x32_bf16 v[156:159], v[84:87], v[56:59], v[156:159]
  v_mfma_f32_16x16x32_bf16 v[184:187], v[84:87], v[60:63], v[184:187]
  v_mfma_f32_16x16x32_bf16 v[212:215], v[84:87], v[64:67], v[212:215]
  v_mfma_f32_16x16x32_bf16 v[240:243], v[84:87], v[68:71], v[240:243]
  v_mfma_f32_16x16x32_bf16 v[160:163], v[88:91], v[56:59], v[160:163]
  v_mfma_f32_16x16x32_bf16 v[188:191], v[88:91], v[60:63], v[188:191]
  v_mfma_f32_16x16x32_bf16 v[216:219], v[88:91], v[64:67], v[216:219]
  v_mfma_f32_16x16x32_bf16 v[244:247], v[88:91], v[68:71], v[244:247]
  v_mfma_f32_16x16x32_bf16 v[164:167], v[92:95], v[56:59], v[164:167]
  v_mfma_f32_16x16x32_bf16 v[192:195], v[92:95], v[60:63], v[192:195]
  v_mfma_f32_16x16x32_bf16 v[220:223], v[92:95], v[64:67], v[220:223]
  v_mfma_f32_16x16x32_bf16 v[248:251], v[92:95], v[68:71], v[248:251]
  v_mfma_f32_16x16x32_bf16 v[168:171], v[96:99], v[56:59], v[168:171]
  v_mfma_f32_16x16x32_bf16 v[196:199], v[96:99], v[60:63], v[196:199]
  v_mfma_f32_16x16x32_bf16 v[224:227], v[96:99], v[64:67], v[224:227]
  v_mfma_f32_16x16x32_bf16 v[252:255], v[96:99], v[68:71], v[252:255]
  s_lshl_b32 s58, s18, 9
  s_lshr_b32 s42, s19, 2
  s_lshl_b32 s42, s42, 7
  s_add_u32 s58, s58, s42
  s_add_u32 s58, s58, 417792
  s_mul_i32 s28, s26, 230400
  s_lshr_b32 s29, s19, 3
  s_mul_i32 s29, s29, 114688
  s_add_u32 s28, s28, s29
  s_add_u32 s28, s28, 48234496
  s_and_b32 s29, s19, 7
  s_mul_i32 s30, s29, 14336
  s_mul_i32 s31, s21, 8192
  s_add_u32 s30, s30, s31
  s_add_u32 s30, s30, s28
  s_add_u32 s30, s30, 0
  s_add_u32 s31, s30, 230400
  v_cvt_pk_bf16_f32 v144, v144, v145
  v_cvt_pk_bf16_f32 v145, v146, v147
  v_cvt_pk_bf16_f32 v146, v148, v149
  v_cvt_pk_bf16_f32 v147, v150, v151
  v_pk_max_i16 v144, v144, 0
  v_pk_max_i16 v145, v145, 0
  v_pk_max_i16 v146, v146, 0
  v_pk_max_i16 v147, v147, 0
  buffer_store_dwordx4 v[144:147], v5, s[8:11], s30 offen offset:0 sc1
  v_cvt_pk_bf16_f32 v172, v172, v173
  v_cvt_pk_bf16_f32 v173, v174, v175
  v_cvt_pk_bf16_f32 v174, v176, v177
  v_cvt_pk_bf16_f32 v175, v178, v179
  v_pk_max_i16 v172, v172, 0
  v_pk_max_i16 v173, v173, 0
  v_pk_max_i16 v174, v174, 0
  v_pk_max_i16 v175, v175, 0
  buffer_store_dwordx4 v[172:175], v5, s[8:11], s30 offen offset:256 sc1
  v_cvt_pk_bf16_f32 v200, v200, v201
  v_cvt_pk_bf16_f32 v201, v202, v203
  v_cvt_pk_bf16_f32 v202, v204, v205
  v_cvt_pk_bf16_f32 v203, v206, v207
  v_pk_max_i16 v200, v200, 0
  v_pk_max_i16 v201, v201, 0
  v_pk_max_i16 v202, v202, 0
  v_pk_max_i16 v203, v203, 0
  buffer_store_dwordx4 v[200:203], v5, s[8:11], s31 offen offset:0 sc1
  v_cvt_pk_bf16_f32 v228, v228, v229
  v_cvt_pk_bf16_f32 v229, v230, v231
  v_cvt_pk_bf16_f32 v230, v232, v233
  v_cvt_pk_bf16_f32 v231, v234, v235
  v_pk_max_i16 v228, v228, 0
  v_pk_max_i16 v229, v229, 0
  v_pk_max_i16 v230, v230, 0
  v_pk_max_i16 v231, v231, 0
  buffer_store_dwordx4 v[228:231], v5, s[8:11], s31 offen offset:256 sc1
  s_mul_i32 s30, s29, 14336
  s_mul_i32 s31, s21, 8192
  s_add_u32 s30, s30, s31
  s_add_u32 s30, s30, s28
  s_add_u32 s30, s30, 2048
  s_add_u32 s31, s30, 230400
  v_cvt_pk_bf16_f32 v152, v152, v153
  v_cvt_pk_bf16_f32 v153, v154, v155
  v_cvt_pk_bf16_f32 v154, v156, v157
  v_cvt_pk_bf16_f32 v155, v158, v159
  v_pk_max_i16 v152, v152, 0
  v_pk_max_i16 v153, v153, 0
  v_pk_max_i16 v154, v154, 0
  v_pk_max_i16 v155, v155, 0
  buffer_store_dwordx4 v[152:155], v5, s[8:11], s30 offen offset:0 sc1
  v_cvt_pk_bf16_f32 v180, v180, v181
  v_cvt_pk_bf16_f32 v181, v182, v183
  v_cvt_pk_bf16_f32 v182, v184, v185
  v_cvt_pk_bf16_f32 v183, v186, v187
  v_pk_max_i16 v180, v180, 0
  v_pk_max_i16 v181, v181, 0
  v_pk_max_i16 v182, v182, 0
  v_pk_max_i16 v183, v183, 0
  buffer_store_dwordx4 v[180:183], v5, s[8:11], s30 offen offset:256 sc1
  v_cvt_pk_bf16_f32 v208, v208, v209
  v_cvt_pk_bf16_f32 v209, v210, v211
  v_cvt_pk_bf16_f32 v210, v212, v213
  v_cvt_pk_bf16_f32 v211, v214, v215
  v_pk_max_i16 v208, v208, 0
  v_pk_max_i16 v209, v209, 0
  v_pk_max_i16 v210, v210, 0
  v_pk_max_i16 v211, v211, 0
  buffer_store_dwordx4 v[208:211], v5, s[8:11], s31 offen offset:0 sc1
  v_cvt_pk_bf16_f32 v236, v236, v237
  v_cvt_pk_bf16_f32 v237, v238, v239
  v_cvt_pk_bf16_f32 v238, v240, v241
  v_cvt_pk_bf16_f32 v239, v242, v243
  v_pk_max_i16 v236, v236, 0
  v_pk_max_i16 v237, v237, 0
  v_pk_max_i16 v238, v238, 0
  v_pk_max_i16 v239, v239, 0
  buffer_store_dwordx4 v[236:239], v5, s[8:11], s31 offen offset:256 sc1
  s_mul_i32 s30, s29, 14336
  s_mul_i32 s31, s21, 8192
  s_add_u32 s30, s30, s31
  s_add_u32 s30, s30, s28
  s_add_u32 s30, s30, 4096
  s_add_u32 s31, s30, 230400
  v_cvt_pk_bf16_f32 v160, v160, v161
  v_cvt_pk_bf16_f32 v161, v162, v163
  v_cvt_pk_bf16_f32 v162, v164, v165
  v_cvt_pk_bf16_f32 v163, v166, v167
  v_pk_max_i16 v160, v160, 0
  v_pk_max_i16 v161, v161, 0
  v_pk_max_i16 v162, v162, 0
  v_pk_max_i16 v163, v163, 0
  buffer_store_dwordx4 v[160:163], v5, s[8:11], s30 offen offset:0 sc1
  v_cvt_pk_bf16_f32 v188, v188, v189
  v_cvt_pk_bf16_f32 v189, v190, v191
  v_cvt_pk_bf16_f32 v190, v192, v193
  v_cvt_pk_bf16_f32 v191, v194, v195
  v_pk_max_i16 v188, v188, 0
  v_pk_max_i16 v189, v189, 0
  v_pk_max_i16 v190, v190, 0
  v_pk_max_i16 v191, v191, 0
  buffer_store_dwordx4 v[188:191], v5, s[8:11], s30 offen offset:256 sc1
  v_cvt_pk_bf16_f32 v216, v216, v217
  v_cvt_pk_bf16_f32 v217, v218, v219
  v_cvt_pk_bf16_f32 v218, v220, v221
  v_cvt_pk_bf16_f32 v219, v222, v223
  v_pk_max_i16 v216, v216, 0
  v_pk_max_i16 v217, v217, 0
  v_pk_max_i16 v218, v218, 0
  v_pk_max_i16 v219, v219, 0
  buffer_store_dwordx4 v[216:219], v5, s[8:11], s31 offen offset:0 sc1
  v_cvt_pk_bf16_f32 v244, v244, v245
  v_cvt_pk_bf16_f32 v245, v246, v247
  v_cvt_pk_bf16_f32 v246, v248, v249
  v_cvt_pk_bf16_f32 v247, v250, v251
  v_pk_max_i16 v244, v244, 0
  v_pk_max_i16 v245, v245, 0
  v_pk_max_i16 v246, v246, 0
  v_pk_max_i16 v247, v247, 0
  buffer_store_dwordx4 v[244:247], v5, s[8:11], s31 offen offset:256 sc1
  s_mul_i32 s30, s29, 14336
  s_mul_i32 s31, s21, 1024
  s_add_u32 s30, s30, s31
  s_add_u32 s30, s30, s28
  s_add_u32 s30, s30, 6144
  s_add_u32 s31, s30, 230400
  v_cvt_pk_bf16_f32 v168, v168, v169
  v_cvt_pk_bf16_f32 v169, v170, v171
  v_cvt_pk_bf16_f32 v170, v196, v197
  v_cvt_pk_bf16_f32 v171, v198, v199
  v_pk_max_i16 v168, v168, 0
  v_pk_max_i16 v169, v169, 0
  v_pk_max_i16 v170, v170, 0
  v_pk_max_i16 v171, v171, 0
  s_nop 1
  v_permlane16_swap_b32 v168, v170
  v_permlane16_swap_b32 v169, v171
  buffer_store_dwordx4 v[168:171], v2, s[8:11], s30 offen sc1
  v_cvt_pk_bf16_f32 v224, v224, v225
  v_cvt_pk_bf16_f32 v225, v226, v227
  v_cvt_pk_bf16_f32 v226, v252, v253
  v_cvt_pk_bf16_f32 v227, v254, v255
  v_pk_max_i16 v224, v224, 0
  v_pk_max_i16 v225, v225, 0
  v_pk_max_i16 v226, v226, 0
  v_pk_max_i16 v227, v227, 0
  s_nop 1
  v_permlane16_swap_b32 v224, v226
  v_permlane16_swap_b32 v225, v227
  buffer_store_dwordx4 v[224:227], v2, s[8:11], s31 offen sc1
  s_barrier
  v_mov_b32 v12, 0
  v_mov_b32 v13, 1
  s_mov_b64 exec, 1
  s_waitcnt vmcnt(0)
  buffer_atomic_add v13, v12, s[8:11], s58 offen sc1
  s_mov_b64 exec, -1
  s_and_b32 s16, s2, 7
  s_lshr_b32 s17, s2, 3
  s_and_b32 s18, s16, 1
  s_lshl_b32 s18, s18, 3
  s_and_b32 s19, s17, 7
  s_add_u32 s18, s18, s19
  s_lshr_b32 s19, s16, 1
  s_lshl_b32 s19, s19, 2
  s_lshr_b32 s17, s17, 3
  s_add_u32 s19, s19, s17
  s_lshr_b32 s17, s19, 3
  s_and_b32 s19, s19, 7
  s_bfe_u32 s20, s3, 0x10001
  s_and_b32 s21, s3, 1
  v_lshrrev_b32 v3, 4, v0
  v_and_b32 v4, 15, v0
  v_lshlrev_b32 v5, 9, v3
  v_lshl_add_u32 v5, v4, 4, v5
  s_mul_i32 s22, s20, 8192
  v_add_u32 v6, s22, v5
  s_mul_i32 s23, s21, 8192
  v_add_u32 v8, s23, v5
  v_mov_b32 v192, 0
  v_mov_b32 v193, 0
  v_mov_b32 v194, 0
  v_mov_b32 v195, 0
  v_mov_b32 v196, 0
  v_mov_b32 v197, 0
  v_mov_b32 v198, 0
  v_mov_b32 v199, 0
  v_mov_b32 v200, 0
  v_mov_b32 v201, 0
  v_mov_b32 v202, 0
  v_mov_b32 v203, 0
  v_mov_b32 v204, 0
  v_mov_b32 v205, 0
  v_mov_b32 v206, 0
  v_mov_b32 v207, 0
  v_mov_b32 v208, 0
  v_mov_b32 v209, 0
  v_mov_b32 v210, 0
  v_mov_b32 v211, 0
  v_mov_b32 v212, 0
  v_mov_b32 v213, 0
  v_mov_b32 v214, 0
  v_mov_b32 v215, 0
  v_mov_b32 v216, 0
  v_mov_b32 v217, 0
  v_mov_b32 v218, 0
  v_mov_b32 v219, 0
  v_mov_b32 v220, 0
  v_mov_b32 v221, 0
  v_mov_b32 v222, 0
  v_mov_b32 v223, 0
  v_mov_b32 v224, 0
  v_mov_b32 v225, 0
  v_mov_b32 v226, 0
  v_mov_b32 v227, 0
  v_mov_b32 v228, 0
  v_mov_b32 v229, 0
  v_mov_b32 v230, 0
  v_mov_b32 v231, 0
  v_mov_b32 v232, 0
  v_mov_b32 v233, 0
  v_mov_b32 v234, 0
  v_mov_b32 v235, 0
  v_mov_b32 v236, 0
  v_mov_b32 v237, 0
  v_mov_b32 v238, 0
  v_mov_b32 v239, 0
  v_mov_b32 v240, 0
  v_mov_b32 v241, 0
  v_mov_b32 v242, 0
  v_mov_b32 v243, 0
  v_mov_b32 v244, 0
  v_mov_b32 v245, 0
  v_mov_b32 v246, 0
  v_mov_b32 v247, 0
  v_mov_b32 v248, 0
  v_mov_b32 v249, 0
  v_mov_b32 v250, 0
  v_mov_b32 v251, 0
  v_mov_b32 v252, 0
  v_mov_b32 v253, 0
  v_mov_b32 v254, 0
  v_mov_b32 v255, 0
  s_mov_b32 s12, s80
  s_and_b32 s13, s81, 0xffff
  s_mov_b32 s14, 4194304
  s_mov_b32 s15, 0x20000
  s_lshl_b32 s26, s18, 2
  s_lshl_b32 s27, s20, 1
  s_add_u32 s26, s26, s27
  v_lshlrev_b32 v18, 11, v4
  v_lshl_add_u32 v18, v3, 4, v18
  v_lshlrev_b32 v19, 5, v3
  s_and_b32 s34, s3, 3
  s_lshl_b32 s35, s2, 2
  s_add_u32 s35, s35, s34
  s_lshl_b32 s36, s35, 13
  s_add_u32 s36, s36, 65011712
  s_xor_b32 s38, s36, 0x20000
  s_lshl_b32 s40, s2, 7
  s_lshl_b32 s41, s34, 2
  s_add_u32 s40, s40, s41
  s_add_u32 s40, s40, 425984
  s_xor_b32 s41, s40, 512
  v_mov_b32 v60, 0
  v_mov_b32 v61, 1
  v_mov_b32 v62, 0
  v_mov_b32 v63, 0
  s_mov_b32 s23, 0
  s_mov_b32 s24, 0
  s_mov_b32 s59, 65536
  s_lshl_b32 s28, s17, 3
  s_add_u32 s28, s28, s19
  s_lshl_b32 s28, s28, 1
  s_add_u32 s28, s28, s21
  s_lshl_b32 s29, s26, 16
  s_lshl_b32 s30, s28, 6
  s_add_u32 s30, s30, s29
  s_mul_i32 s29, s26, 66560
  v_add_u32 v14, s23, v6
  v_add_u32 v16, s59, v8
  s_barrier
  ds_read_b128 v[64:67], v14 offset:0
  ds_read_b128 v[68:71], v14 offset:256
  ds_read_b128 v[72:75], v14 offset:4096
  ds_read_b128 v[76:79], v14 offset:4352
  ds_read_b128 v[80:83], v16 offset:0
  ds_read_b128 v[84:87], v16 offset:256
  ds_read_b128 v[88:91], v16 offset:4096
  ds_read_b128 v[92:95], v16 offset:4352
  ds_read_b128 v[96:99], v14 offset:2048
  ds_read_b128 v[100:103], v14 offset:2304
  ds_read_b128 v[104:107], v14 offset:6144
  ds_read_b128 v[108:111], v14 offset:6400
  ds_read_b128 v[112:115], v16 offset:2048
  ds_read_b128 v[116:119], v16 offset:2304
  ds_read_b128 v[120:123], v16 offset:6144
  ds_read_b128 v[124:127], v16 offset:6400
  s_add_u32 s23, s23, 16384
  s_cmp_eq_u32 s23, 65536
  s_cselect_b32 s23, 0, s23
  s_add_u32 s59, s59, 16384
  s_cmp_eq_u32 s59, 163840
  s_cselect_b32 s59, 65536, s59
  v_add_u32 v14, s23, v6
  v_add_u32 v16, s59, v8
  s_branch L_adaL_ffn2C_cmid
L_adaL_ffn2C_cloop:
  s_barrier
  v_mfma_f32_16x16x32_bf16 v[192:195], v[144:147], v[128:131], v[192:195]
  ds_read_b128 v[64:67], v14 offset:0
  v_mfma_f32_16x16x32_bf16 v[208:211], v[144:147], v[132:135], v[208:211]
  ds_read_b128 v[68:71], v14 offset:256
  v_mfma_f32_16x16x32_bf16 v[224:227], v[144:147], v[136:139], v[224:227]
  ds_read_b128 v[72:75], v14 offset:4096
  v_mfma_f32_16x16x32_bf16 v[240:243], v[144:147], v[140:143], v[240:243]
  ds_read_b128 v[76:79], v14 offset:4352
  v_mfma_f32_16x16x32_bf16 v[196:199], v[148:151], v[128:131], v[196:199]
  ds_read_b128 v[80:83], v16 offset:0
  v_mfma_f32_16x16x32_bf16 v[212:215], v[148:151], v[132:135], v[212:215]
  ds_read_b128 v[84:87], v16 offset:256
  v_mfma_f32_16x16x32_bf16 v[228:231], v[148:151], v[136:139], v[228:231]
  ds_read_b128 v[88:91], v16 offset:4096
  v_mfma_f32_16x16x32_bf16 v[244:247], v[148:151], v[140:143], v[244:247]
  ds_read_b128 v[92:95], v16 offset:4352
  v_mfma_f32_16x16x32_bf16 v[200:203], v[152:155], v[128:131], v[200:203]
  ds_read_b128 v[96:99], v14 offset:2048
  v_mfma_f32_16x16x32_bf16 v[216:219], v[152:155], v[132:135], v[216:219]
  ds_read_b128 v[100:103], v14 offset:2304
  v_mfma_f32_16x16x32_bf16 v[232:235], v[152:155], v[136:139], v[232:235]
  ds_read_b128 v[104:107], v14 offset:6144
  v_mfma_f32_16x16x32_bf16 v[248:251], v[152:155], v[140:143], v[248:251]
  ds_read_b128 v[108:111], v14 offset:6400
  v_mfma_f32_16x16x32_bf16 v[204:207], v[156:159], v[128:131], v[204:207]
  ds_read_b128 v[112:115], v16 offset:2048
  v_mfma_f32_16x16x32_bf16 v[220:223], v[156:159], v[132:135], v[220:223]
  ds_read_b128 v[116:119], v16 offset:2304
  v_mfma_f32_16x16x32_bf16 v[236:239], v[156:159], v[136:139], v[236:239]
  ds_read_b128 v[120:123], v16 offset:6144
  v_mfma_f32_16x16x32_bf16 v[252:255], v[156:159], v[140:143], v[252:255]
  ds_read_b128 v[124:127], v16 offset:6400
  v_mfma_f32_16x16x32_bf16 v[192:195], v[176:179], v[160:163], v[192:195]
  s_add_u32 s23, s23, 16384
  v_mfma_f32_16x16x32_bf16 v[208:211], v[176:179], v[164:167], v[208:211]
  s_cmp_eq_u32 s23, 65536
  v_mfma_f32_16x16x32_bf16 v[224:227], v[176:179], v[168:171], v[224:227]
  s_cselect_b32 s23, 0, s23
  v_mfma_f32_16x16x32_bf16 v[240:243], v[176:179], v[172:175], v[240:243]
  s_add_u32 s59, s59, 16384
  v_mfma_f32_16x16x32_bf16 v[196:199], v[180:183], v[160:163], v[196:199]
  s_cmp_eq_u32 s59, 163840
  v_mfma_f32_16x16x32_bf16 v[212:215], v[180:183], v[164:167], v[212:215]
  s_cselect_b32 s59, 65536, s59
  v_mfma_f32_16x16x32_bf16 v[228:231], v[180:183], v[168:171], v[228:231]
  v_add_u32 v14, s23, v6
  v_mfma_f32_16x16x32_bf16 v[244:247], v[180:183], v[172:175], v[244:247]
  v_add_u32 v16, s59, v8
  v_mfma_f32_16x16x32_bf16 v[200:203], v[184:187], v[160:163], v[200:203]
  v_mfma_f32_16x16x32_bf16 v[216:219], v[184:187], v[164:167], v[216:219]
  v_mfma_f32_16x16x32_bf16 v[232:235], v[184:187], v[168:171], v[232:235]
  v_mfma_f32_16x16x32_bf16 v[248:251], v[184:187], v[172:175], v[248:251]
  v_mfma_f32_16x16x32_bf16 v[204:207], v[188:191], v[160:163], v[204:207]
  v_mfma_f32_16x16x32_bf16 v[220:223], v[188:191], v[164:167], v[220:223]
  v_mfma_f32_16x16x32_bf16 v[236:239], v[188:191], v[168:171], v[236:239]
  v_mfma_f32_16x16x32_bf16 v[252:255], v[188:191], v[172:175], v[252:255]
L_adaL_ffn2C_cmid:
  s_waitcnt lgkmcnt(0)
  s_barrier
  v_mfma_f32_16x16x32_bf16 v[192:195], v[80:83], v[64:67], v[192:195]
  ds_read_b128 v[128:131], v14 offset:0
  v_mfma_f32_16x16x32_bf16 v[208:211], v[80:83], v[68:71], v[208:211]
  ds_read_b128 v[132:135], v14 offset:256
  v_mfma_f32_16x16x32_bf16 v[224:227], v[80:83], v[72:75], v[224:227]
  ds_read_b128 v[136:139], v14 offset:4096
  v_mfma_f32_16x16x32_bf16 v[240:243], v[80:83], v[76:79], v[240:243]
  ds_read_b128 v[140:143], v14 offset:4352
  v_mfma_f32_16x16x32_bf16 v[196:199], v[84:87], v[64:67], v[196:199]
  ds_read_b128 v[144:147], v16 offset:0
  v_mfma_f32_16x16x32_bf16 v[212:215], v[84:87], v[68:71], v[212:215]
  ds_read_b128 v[148:151], v16 offset:256
  v_mfma_f32_16x16x32_bf16 v[228:231], v[84:87], v[72:75], v[228:231]
  ds_read_b128 v[152:155], v16 offset:4096
  v_mfma_f32_16x16x32_bf16 v[244:247], v[84:87], v[76:79], v[244:247]
  ds_read_b128 v[156:159], v16 offset:4352
  v_mfma_f32_16x16x32_bf16 v[200:203], v[88:91], v[64:67], v[200:203]
  ds_read_b128 v[160:163], v14 offset:2048
  v_mfma_f32_16x16x32_bf16 v[216:219], v[88:91], v[68:71], v[216:219]
  ds_read_b128 v[164:167], v14 offset:2304
  v_mfma_f32_16x16x32_bf16 v[232:235], v[88:91], v[72:75], v[232:235]
  ds_read_b128 v[168:171], v14 offset:6144
  v_mfma_f32_16x16x32_bf16 v[248:251], v[88:91], v[76:79], v[248:251]
  ds_read_b128 v[172:175], v14 offset:6400
  v_mfma_f32_16x16x32_bf16 v[204:207], v[92:95], v[64:67], v[204:207]
  ds_read_b128 v[176:179], v16 offset:2048
  v_mfma_f32_16x16x32_bf16 v[220:223], v[92:95], v[68:71], v[220:223]
  ds_read_b128 v[180:183], v16 offset:2304
  v_mfma_f32_16x16x32_bf16 v[236:239], v[92:95], v[72:75], v[236:239]
  ds_read_b128 v[184:187], v16 offset:6144
  v_mfma_f32_16x16x32_bf16 v[252:255], v[92:95], v[76:79], v[252:255]
  ds_read_b128 v[188:191], v16 offset:6400
  v_mfma_f32_16x16x32_bf16 v[192:195], v[112:115], v[96:99], v[192:195]
  s_add_u32 s23, s23, 16384
  v_mfma_f32_16x16x32_bf16 v[208:211], v[112:115], v[100:103], v[208:211]
  s_cmp_eq_u32 s23, 65536
  v_mfma_f32_16x16x32_bf16 v[224:227], v[112:115], v[104:107], v[224:227]
  s_cselect_b32 s23, 0, s23
  v_mfma_f32_16x16x32_bf16 v[240:243], v[112:115], v[108:111], v[240:243]
  s_add_u32 s59, s59, 16384
  v_mfma_f32_16x16x32_bf16 v[196:199], v[116:119], v[96:99], v[196:199]
  s_cmp_eq_u32 s59, 163840
  v_mfma_f32_16x16x32_bf16 v[212:215], v[116:119], v[100:103], v[212:215]
  s_cselect_b32 s59, 65536, s59
  v_mfma_f32_16x16x32_bf16 v[228:231], v[116:119], v[104:107], v[228:231]
  v_add_u32 v14, s23, v6
  v_mfma_f32_16x16x32_bf16 v[244:247], v[116:119], v[108:111], v[244:247]
  v_add_u32 v16, s59, v8
  v_mfma_f32_16x16x32_bf16 v[200:203], v[120:123], v[96:99], v[200:203]
  s_add_u32 s24, s24, 1
  v_mfma_f32_16x16x32_bf16 v[216:219], v[120:123], v[100:103], v[216:219]
  v_mfma_f32_16x16x32_bf16 v[232:235], v[120:123], v[104:107], v[232:235]
  v_mfma_f32_16x16x32_bf16 v[248:251], v[120:123], v[108:111], v[248:251]
  v_mfma_f32_16x16x32_bf16 v[204:207], v[124:127], v[96:99], v[204:207]
  v_mfma_f32_16x16x32_bf16 v[220:223], v[124:127], v[100:103], v[220:223]
  v_mfma_f32_16x16x32_bf16 v[236:239], v[124:127], v[104:107], v[236:239]
  v_mfma_f32_16x16x32_bf16 v[252:255], v[124:127], v[108:111], v[252:255]
  s_cmp_eq_u32 s24, 3
  s_cbranch_scc1 L_adaL_ffn2C_hook
L_adaL_ffn2C_hookr:
  s_cmp_lt_u32 s24, 12
  s_waitcnt lgkmcnt(0)
  s_cbranch_scc1 L_adaL_ffn2C_cloop
  s_barrier
  v_mfma_f32_16x16x32_bf16 v[192:195], v[144:147], v[128:131], v[192:195]
  ds_read_b128 v[64:67], v14 offset:0
  v_mfma_f32_16x16x32_bf16 v[208:211], v[144:147], v[132:135], v[208:211]
  ds_read_b128 v[68:71], v14 offset:256
  v_mfma_f32_16x16x32_bf16 v[224:227], v[144:147], v[136:139], v[224:227]
  ds_read_b128 v[72:75], v14 offset:4096
  v_mfma_f32_16x16x32_bf16 v[240:243], v[144:147], v[140:143], v[240:243]
  ds_read_b128 v[76:79], v14 offset:4352
  v_mfma_f32_16x16x32_bf16 v[196:199], v[148:151], v[128:131], v[196:199]
  ds_read_b128 v[80:83], v16 offset:0
  v_mfma_f32_16x16x32_bf16 v[212:215], v[148:151], v[132:135], v[212:215]
  ds_read_b128 v[84:87], v16 offset:256
  v_mfma_f32_16x16x32_bf16 v[228:231], v[148:151], v[136:139], v[228:231]
  ds_read_b128 v[96:99], v14 offset:2048
  v_mfma_f32_16x16x32_bf16 v[244:247], v[148:151], v[140:143], v[244:247]
  ds_read_b128 v[100:103], v14 offset:2304
  v_mfma_f32_16x16x32_bf16 v[200:203], v[152:155], v[128:131], v[200:203]
  ds_read_b128 v[104:107], v14 offset:6144
  v_mfma_f32_16x16x32_bf16 v[216:219], v[152:155], v[132:135], v[216:219]
  ds_read_b128 v[108:111], v14 offset:6400
  v_mfma_f32_16x16x32_bf16 v[232:235], v[152:155], v[136:139], v[232:235]
  ds_read_b128 v[112:115], v16 offset:2048
  v_mfma_f32_16x16x32_bf16 v[248:251], v[152:155], v[140:143], v[248:251]
  ds_read_b128 v[116:119], v16 offset:2304
  v_mfma_f32_16x16x32_bf16 v[204:207], v[156:159], v[128:131], v[204:207]
  s_add_u32 s23, s23, 16384
  v_mfma_f32_16x16x32_bf16 v[220:223], v[156:159], v[132:135], v[220:223]
  s_cmp_eq_u32 s23, 65536
  v_mfma_f32_16x16x32_bf16 v[236:239], v[156:159], v[136:139], v[236:239]
  s_cselect_b32 s23, 0, s23
  v_mfma_f32_16x16x32_bf16 v[252:255], v[156:159], v[140:143], v[252:255]
  s_add_u32 s59, s59, 16384
  v_mfma_f32_16x16x32_bf16 v[192:195], v[176:179], v[160:163], v[192:195]
  s_cmp_eq_u32 s59, 163840
  v_mfma_f32_16x16x32_bf16 v[208:211], v[176:179], v[164:167], v[208:211]
  s_cselect_b32 s59, 65536, s59
  v_mfma_f32_16x16x32_bf16 v[224:227], v[176:179], v[168:171], v[224:227]
  v_add_u32 v14, s23, v6
  v_mfma_f32_16x16x32_bf16 v[240:243], v[176:179], v[172:175], v[240:243]
  v_add_u32 v16, s59, v8
  v_mfma_f32_16x16x32_bf16 v[196:199], v[180:183], v[160:163], v[196:199]
  v_mfma_f32_16x16x32_bf16 v[212:215], v[180:183], v[164:167], v[212:215]
  v_mfma_f32_16x16x32_bf16 v[228:231], v[180:183], v[168:171], v[228:231]
  v_mfma_f32_16x16x32_bf16 v[244:247], v[180:183], v[172:175], v[244:247]
  v_mfma_f32_16x16x32_bf16 v[200:203], v[184:187], v[160:163], v[200:203]
  v_mfma_f32_16x16x32_bf16 v[216:219], v[184:187], v[164:167], v[216:219]
  v_mfma_f32_16x16x32_bf16 v[232:235], v[184:187], v[168:171], v[232:235]
  v_mfma_f32_16x16x32_bf16 v[248:251], v[184:187], v[172:175], v[248:251]
  v_mfma_f32_16x16x32_bf16 v[204:207], v[188:191], v[160:163], v[204:207]
  v_mfma_f32_16x16x32_bf16 v[220:223], v[188:191], v[164:167], v[220:223]
  v_mfma_f32_16x16x32_bf16 v[236:239], v[188:191], v[168:171], v[236:239]
  v_mfma_f32_16x16x32_bf16 v[252:255], v[188:191], v[172:175], v[252:255]
  s_waitcnt lgkmcnt(0)
  s_barrier
  v_mfma_f32_16x16x32_bf16 v[192:195], v[80:83], v[64:67], v[192:195]
  ds_read_b128 v[128:131], v14 offset:0
  ds_read_b128 v[132:135], v14 offset:256
  v_mfma_f32_16x16x32_bf16 v[208:211], v[80:83], v[68:71], v[208:211]
  ds_read_b128 v[136:139], v14 offset:4096
  ds_read_b128 v[140:143], v14 offset:4352
  v_mfma_f32_16x16x32_bf16 v[224:227], v[80:83], v[72:75], v[224:227]
  ds_read_b128 v[144:147], v16 offset:0
  ds_read_b128 v[148:151], v16 offset:256
  v_mfma_f32_16x16x32_bf16 v[240:243], v[80:83], v[76:79], v[240:243]
  ds_read_b128 v[160:163], v14 offset:2048
  ds_read_b128 v[164:167], v14 offset:2304
  v_mfma_f32_16x16x32_bf16 v[196:199], v[84:87], v[64:67], v[196:199]
  ds_read_b128 v[168:171], v14 offset:6144
  ds_read_b128 v[172:175], v14 offset:6400
  v_mfma_f32_16x16x32_bf16 v[212:215], v[84:87], v[68:71], v[212:215]
  ds_read_b128 v[176:179], v16 offset:2048
  ds_read_b128 v[180:183], v16 offset:2304
  v_mfma_f32_16x16x32_bf16 v[228:231], v[84:87], v[72:75], v[228:231]
  s_add_u32 s23, s23, 16384
  s_cmp_eq_u32 s23, 65536
  v_mfma_f32_16x16x32_bf16 v[244:247], v[84:87], v[76:79], v[244:247]
  s_cselect_b32 s23, 0, s23
  s_add_u32 s59, s59, 16384
  v_mfma_f32_16x16x32_bf16 v[192:195], v[112:115], v[96:99], v[192:195]
  s_cmp_eq_u32 s59, 163840
  s_cselect_b32 s59, 65536, s59
  v_mfma_f32_16x16x32_bf16 v[208:211], v[112:115], v[100:103], v[208:211]
  v_add_u32 v14, s23, v6
  v_add_u32 v16, s59, v8
  v_mfma_f32_16x16x32_bf16 v[224:227], v[112:115], v[104:107], v[224:227]
  v_cvt_pk_bf16_f32 v200, v200, v201
  v_cvt_pk_bf16_f32 v201, v202, v203
  v_mfma_f32_16x16x32_bf16 v[240:243], v[112:115], v[108:111], v[240:243]
  v_cvt_pk_bf16_f32 v202, v204, v205
  v_cvt_pk_bf16_f32 v203, v206, v207
  v_mfma_f32_16x16x32_bf16 v[196:199], v[116:119], v[96:99], v[196:199]
  buffer_store_dwordx4 v[200:203], v2, s[8:11], s36 offen offset:0 sc0 sc1
  v_cvt_pk_bf16_f32 v216, v216, v217
  v_mfma_f32_16x16x32_bf16 v[212:215], v[116:119], v[100:103], v[212:215]
  v_cvt_pk_bf16_f32 v217, v218, v219
  v_cvt_pk_bf16_f32 v218, v220, v221
  v_mfma_f32_16x16x32_bf16 v[228:231], v[116:119], v[104:107], v[228:231]
  v_cvt_pk_bf16_f32 v219, v222, v223
  buffer_store_dwordx4 v[216:219], v2, s[8:11], s36 offen offset:1024 sc0 sc1
  v_mfma_f32_16x16x32_bf16 v[244:247], v[116:119], v[108:111], v[244:247]
  v_cvt_pk_bf16_f32 v232, v232, v233
  v_cvt_pk_bf16_f32 v233, v234, v235
  v_cvt_pk_bf16_f32 v234, v236, v237
  v_cvt_pk_bf16_f32 v235, v238, v239
  buffer_store_dwordx4 v[232:235], v2, s[8:11], s36 offen offset:2048 sc0 sc1
  v_cvt_pk_bf16_f32 v248, v248, v249
  v_cvt_pk_bf16_f32 v249, v250, v251
  v_cvt_pk_bf16_f32 v250, v252, v253
  v_cvt_pk_bf16_f32 v251, v254, v255
  buffer_store_dwordx4 v[248:251], v2, s[8:11], s36 offen offset:3072 sc0 sc1
  s_waitcnt lgkmcnt(0)
  s_barrier
  v_mfma_f32_16x16x32_bf16 v[192:195], v[144:147], v[128:131], v[192:195]
  ds_read_b128 v[64:67], v14 offset:0
  ds_read_b128 v[68:71], v14 offset:256
  v_mfma_f32_16x16x32_bf16 v[208:211], v[144:147], v[132:135], v[208:211]
  ds_read_b128 v[72:75], v14 offset:4096
  ds_read_b128 v[76:79], v14 offset:4352
  v_mfma_f32_16x16x32_bf16 v[224:227], v[144:147], v[136:139], v[224:227]
  ds_read_b128 v[80:83], v16 offset:0
  ds_read_b128 v[84:87], v16 offset:256
  v_mfma_f32_16x16x32_bf16 v[240:243], v[144:147], v[140:143], v[240:243]
  ds_read_b128 v[96:99], v14 offset:2048
  ds_read_b128 v[100:103], v14 offset:2304
  v_mfma_f32_16x16x32_bf16 v[196:199], v[148:151], v[128:131], v[196:199]
  ds_read_b128 v[104:107], v14 offset:6144
  ds_read_b128 v[108:111], v14 offset:6400
  v_mfma_f32_16x16x32_bf16 v[212:215], v[148:151], v[132:135], v[212:215]
  ds_read_b128 v[112:115], v16 offset:2048
  ds_read_b128 v[116:119], v16 offset:2304
  v_mfma_f32_16x16x32_bf16 v[228:231], v[148:151], v[136:139], v[228:231]
  s_add_u32 s23, s23, 16384
  s_cmp_eq_u32 s23, 65536
  v_mfma_f32_16x16x32_bf16 v[244:247], v[148:151], v[140:143], v[244:247]
  s_cselect_b32 s23, 0, s23
  s_add_u32 s59, s59, 16384
  v_mfma_f32_16x16x32_bf16 v[192:195], v[176:179], v[160:163], v[192:195]
  s_cmp_eq_u32 s59, 163840
  s_cselect_b32 s59, 65536, s59
  v_mfma_f32_16x16x32_bf16 v[208:211], v[176:179], v[164:167], v[208:211]
  v_add_u32 v14, s23, v6
  v_add_u32 v16, s59, v8
  v_mfma_f32_16x16x32_bf16 v[224:227], v[176:179], v[168:171], v[224:227]
  v_mfma_f32_16x16x32_bf16 v[240:243], v[176:179], v[172:175], v[240:243]
  v_mfma_f32_16x16x32_bf16 v[196:199], v[180:183], v[160:163], v[196:199]
  v_mfma_f32_16x16x32_bf16 v[212:215], v[180:183], v[164:167], v[212:215]
  v_mfma_f32_16x16x32_bf16 v[228:231], v[180:183], v[168:171], v[228:231]
  v_mfma_f32_16x16x32_bf16 v[244:247], v[180:183], v[172:175], v[244:247]
  s_waitcnt lgkmcnt(0)
  s_barrier
  s_mov_b64 exec, 1
  s_waitcnt vmcnt(0)
  buffer_atomic_add v61, v60, s[8:11], s40 offen sc1
  s_mov_b64 exec, -1
  s_nop 0
  v_mfma_f32_16x16x32_bf16 v[192:195], v[80:83], v[64:67], v[192:195]
  ds_read_b128 v[128:131], v14 offset:0
  ds_read_b128 v[132:135], v14 offset:256
  v_mfma_f32_16x16x32_bf16 v[208:211], v[80:83], v[68:71], v[208:211]
  ds_read_b128 v[136:139], v14 offset:4096
  ds_read_b128 v[140:143], v14 offset:4352
  v_mfma_f32_16x16x32_bf16 v[224:227], v[80:83], v[72:75], v[224:227]
  ds_read_b128 v[144:147], v16 offset:0
  ds_read_b128 v[148:151], v16 offset:256
  v_mfma_f32_16x16x32_bf16 v[240:243], v[80:83], v[76:79], v[240:243]
  ds_read_b128 v[160:163], v14 offset:2048
  ds_read_b128 v[164:167], v14 offset:2304
  v_mfma_f32_16x16x32_bf16 v[196:199], v[84:87], v[64:67], v[196:199]
  ds_read_b128 v[168:171], v14 offset:6144
  ds_read_b128 v[172:175], v14 offset:6400
  v_mfma_f32_16x16x32_bf16 v[212:215], v[84:87], v[68:71], v[212:215]
  ds_read_b128 v[176:179], v16 offset:2048
  ds_read_b128 v[180:183], v16 offset:2304
  v_mfma_f32_16x16x32_bf16 v[228:231], v[84:87], v[72:75], v[228:231]
  s_add_u32 s23, s23, 16384
  s_cmp_eq_u32 s23, 65536
  v_mfma_f32_16x16x32_bf16 v[244:247], v[84:87], v[76:79], v[244:247]
  s_cselect_b32 s23, 0, s23
  s_add_u32 s59, s59, 16384
  v_mfma_f32_16x16x32_bf16 v[192:195], v[112:115], v[96:99], v[192:195]
  s_cmp_eq_u32 s59, 163840
  s_cselect_b32 s59, 65536, s59
  v_mfma_f32_16x16x32_bf16 v[208:211], v[112:115], v[100:103], v[208:211]
  v_add_u32 v14, s23, v6
  v_add_u32 v16, s59, v8
  v_mfma_f32_16x16x32_bf16 v[224:227], v[112:115], v[104:107], v[224:227]
  v_mfma_f32_16x16x32_bf16 v[240:243], v[112:115], v[108:111], v[240:243]
  v_mfma_f32_16x16x32_bf16 v[196:199], v[116:119], v[96:99], v[196:199]
  v_mfma_f32_16x16x32_bf16 v[212:215], v[116:119], v[100:103], v[212:215]
  v_mfma_f32_16x16x32_bf16 v[228:231], v[116:119], v[104:107], v[228:231]
  v_mfma_f32_16x16x32_bf16 v[244:247], v[116:119], v[108:111], v[244:247]
  s_waitcnt lgkmcnt(0)
  s_barrier
  v_mfma_f32_16x16x32_bf16 v[192:195], v[144:147], v[128:131], v[192:195]
  ds_read_b128 v[64:67], v14 offset:0
  ds_read_b128 v[68:71], v14 offset:256
  v_mfma_f32_16x16x32_bf16 v[208:211], v[144:147], v[132:135], v[208:211]
  ds_read_b128 v[72:75], v14 offset:4096
  ds_read_b128 v[76:79], v14 offset:4352
  v_mfma_f32_16x16x32_bf16 v[224:227], v[144:147], v[136:139], v[224:227]
  ds_read_b128 v[80:83], v16 offset:0
  ds_read_b128 v[84:87], v16 offset:256
  v_mfma_f32_16x16x32_bf16 v[240:243], v[144:147], v[140:143], v[240:243]
  ds_read_b128 v[96:99], v14 offset:2048
  ds_read_b128 v[100:103], v14 offset:2304
  v_mfma_f32_16x16x32_bf16 v[196:199], v[148:151], v[128:131], v[196:199]
  ds_read_b128 v[104:107], v14 offset:6144
  ds_read_b128 v[108:111], v14 offset:6400
  v_mfma_f32_16x16x32_bf16 v[212:215], v[148:151], v[132:135], v[212:215]
  ds_read_b128 v[112:115], v16 offset:2048
  ds_read_b128 v[116:119], v16 offset:2304
  v_mfma_f32_16x16x32_bf16 v[228:231], v[148:151], v[136:139], v[228:231]
  s_add_u32 s23, s23, 16384
  s_cmp_eq_u32 s23, 65536
  v_mfma_f32_16x16x32_bf16 v[244:247], v[148:151], v[140:143], v[244:247]
  s_cselect_b32 s23, 0, s23
  s_add_u32 s59, s59, 16384
  v_mfma_f32_16x16x32_bf16 v[192:195], v[176:179], v[160:163], v[192:195]
  s_cmp_eq_u32 s59, 163840
  s_cselect_b32 s59, 65536, s59
  v_mfma_f32_16x16x32_bf16 v[208:211], v[176:179], v[164:167], v[208:211]
  v_add_u32 v14, s23, v6
  v_add_u32 v16, s59, v8
  v_mfma_f32_16x16x32_bf16 v[224:227], v[176:179], v[168:171], v[224:227]
  v_mfma_f32_16x16x32_bf16 v[240:243], v[176:179], v[172:175], v[240:243]
  v_mfma_f32_16x16x32_bf16 v[196:199], v[180:183], v[160:163], v[196:199]
  v_mfma_f32_16x16x32_bf16 v[212:215], v[180:183], v[164:167], v[212:215]
  v_mfma_f32_16x16x32_bf16 v[228:231], v[180:183], v[168:171], v[228:231]
  v_mfma_f32_16x16x32_bf16 v[244:247], v[180:183], v[172:175], v[244:247]
  s_waitcnt lgkmcnt(0)
  s_barrier
  s_mov_b64 exec, 1
  buffer_atomic_add v63, v62, s[8:11], s41 offen sc0 sc1
  s_mov_b64 exec, -1
  s_nop 0
  v_mfma_f32_16x16x32_bf16 v[192:195], v[80:83], v[64:67], v[192:195]
  ds_read_b128 v[128:131], v14 offset:0
  ds_read_b128 v[132:135], v14 offset:256
  v_mfma_f32_16x16x32_bf16 v[208:211], v[80:83], v[68:71], v[208:211]
  ds_read_b128 v[136:139], v14 offset:4096
  ds_read_b128 v[140:143], v14 offset:4352
  v_mfma_f32_16x16x32_bf16 v[224:227], v[80:83], v[72:75], v[224:227]
  ds_read_b128 v[144:147], v16 offset:0
  ds_read_b128 v[148:151], v16 offset:256
  v_mfma_f32_16x16x32_bf16 v[240:243], v[80:83], v[76:79], v[240:243]
  ds_read_b128 v[160:163], v14 offset:2048
  ds_read_b128 v[164:167], v14 offset:2304
  v_mfma_f32_16x16x32_bf16 v[196:199], v[84:87], v[64:67], v[196:199]
  ds_read_b128 v[168:171], v14 offset:6144
  ds_read_b128 v[172:175], v14 offset:6400
  v_mfma_f32_16x16x32_bf16 v[212:215], v[84:87], v[68:71], v[212:215]
  ds_read_b128 v[176:179], v16 offset:2048
  ds_read_b128 v[180:183], v16 offset:2304
  v_mfma_f32_16x16x32_bf16 v[228:231], v[84:87], v[72:75], v[228:231]
  s_add_u32 s23, s23, 16384
  s_cmp_eq_u32 s23, 65536
  v_mfma_f32_16x16x32_bf16 v[244:247], v[84:87], v[76:79], v[244:247]
  s_cselect_b32 s23, 0, s23
  s_add_u32 s59, s59, 16384
  v_mfma_f32_16x16x32_bf16 v[192:195], v[112:115], v[96:99], v[192:195]
  s_cmp_eq_u32 s59, 163840
  s_cselect_b32 s59, 65536, s59
  v_mfma_f32_16x16x32_bf16 v[208:211], v[112:115], v[100:103], v[208:211]
  v_add_u32 v14, s23, v6
  v_add_u32 v16, s59, v8
  v_mfma_f32_16x16x32_bf16 v[224:227], v[112:115], v[104:107], v[224:227]
  v_mfma_f32_16x16x32_bf16 v[240:243], v[112:115], v[108:111], v[240:243]
  v_mfma_f32_16x16x32_bf16 v[196:199], v[116:119], v[96:99], v[196:199]
  v_mfma_f32_16x16x32_bf16 v[212:215], v[116:119], v[100:103], v[212:215]
  v_mfma_f32_16x16x32_bf16 v[228:231], v[116:119], v[104:107], v[228:231]
  v_mfma_f32_16x16x32_bf16 v[244:247], v[116:119], v[108:111], v[244:247]
  s_waitcnt lgkmcnt(0)
  s_barrier
  v_mfma_f32_16x16x32_bf16 v[192:195], v[144:147], v[128:131], v[192:195]
  ds_read_b128 v[64:67], v14 offset:0
  ds_read_b128 v[68:71], v14 offset:256
  v_mfma_f32_16x16x32_bf16 v[208:211], v[144:147], v[132:135], v[208:211]
  ds_read_b128 v[72:75], v14 offset:4096
  ds_read_b128 v[76:79], v14 offset:4352
  v_mfma_f32_16x16x32_bf16 v[224:227], v[144:147], v[136:139], v[224:227]
  ds_read_b128 v[80:83], v16 offset:0
  ds_read_b128 v[84:87], v16 offset:256
  v_mfma_f32_16x16x32_bf16 v[240:243], v[144:147], v[140:143], v[240:243]
  ds_read_b128 v[96:99], v14 offset:2048
  ds_read_b128 v[100:103], v14 offset:2304
  v_mfma_f32_16x16x32_bf16 v[196:199], v[148:151], v[128:131], v[196:199]
  ds_read_b128 v[104:107], v14 offset:6144
  ds_read_b128 v[108:111], v14 offset:6400
  v_mfma_f32_16x16x32_bf16 v[212:215], v[148:151], v[132:135], v[212:215]
  ds_read_b128 v[112:115], v16 offset:2048
  ds_read_b128 v[116:119], v16 offset:2304
  v_mfma_f32_16x16x32_bf16 v[228:231], v[148:151], v[136:139], v[228:231]
  s_add_u32 s23, s23, 16384
  s_cmp_eq_u32 s23, 65536
  v_mfma_f32_16x16x32_bf16 v[244:247], v[148:151], v[140:143], v[244:247]
  s_cselect_b32 s23, 0, s23
  s_add_u32 s59, s59, 16384
  v_mfma_f32_16x16x32_bf16 v[192:195], v[176:179], v[160:163], v[192:195]
  s_cmp_eq_u32 s59, 163840
  s_cselect_b32 s59, 65536, s59
  v_mfma_f32_16x16x32_bf16 v[208:211], v[176:179], v[164:167], v[208:211]
  v_add_u32 v14, s23, v6
  v_add_u32 v16, s59, v8
  v_mfma_f32_16x16x32_bf16 v[224:227], v[176:179], v[168:171], v[224:227]
  v_mfma_f32_16x16x32_bf16 v[240:243], v[176:179], v[172:175], v[240:243]
  v_mfma_f32_16x16x32_bf16 v[196:199], v[180:183], v[160:163], v[196:199]
  v_mfma_f32_16x16x32_bf16 v[212:215], v[180:183], v[164:167], v[212:215]
  v_mfma_f32_16x16x32_bf16 v[228:231], v[180:183], v[168:171], v[228:231]
  v_mfma_f32_16x16x32_bf16 v[244:247], v[180:183], v[172:175], v[244:247]
  s_waitcnt lgkmcnt(0)
  s_barrier
  s_waitcnt vmcnt(0)
  v_readfirstlane_b32 s53, v63
  s_nop 0
  s_cmp_ge_u32 s53, 1
  s_cbranch_scc1 L_adaL_ffn2C_xok
  v_lshlrev_b32 v62, 7, v0
  s_mov_b32 s62, 0
  s_mov_b64 exec, 1
L_adaL_ffn2C_poll:
  v_mov_b32 v63, 0
  buffer_atomic_add v63, v62, s[8:11], s41 offen sc0 sc1
  s_add_u32 s62, s62, 1
  s_cmp_gt_u32 s62, 0x80000
  s_cbranch_scc1 L_adaL_ffn2C_pollx
  s_waitcnt vmcnt(0)
  v_cmp_gt_u32 vcc, 1, v63
  s_nop 3
  s_cbranch_vccz L_adaL_ffn2C_pollx
  s_sleep 2
  s_branch L_adaL_ffn2C_poll
L_adaL_ffn2C_pollx:
  s_mov_b64 exec, -1
L_adaL_ffn2C_xok:
  buffer_load_dwordx4 v[200:203], v2, s[8:11], s38 offen offset:0 sc0 sc1
  buffer_load_dwordx4 v[216:219], v2, s[8:11], s38 offen offset:1024 sc0 sc1
  buffer_load_dwordx4 v[232:235], v2, s[8:11], s38 offen offset:2048 sc0 sc1
  buffer_load_dwordx4 v[248:251], v2, s[8:11], s38 offen offset:3072 sc0 sc1
  v_mfma_f32_16x16x32_bf16 v[192:195], v[80:83], v[64:67], v[192:195]
  ds_read_b128 v[128:131], v14 offset:0
  ds_read_b128 v[132:135], v14 offset:256
  v_mfma_f32_16x16x32_bf16 v[208:211], v[80:83], v[68:71], v[208:211]
  ds_read_b128 v[136:139], v14 offset:4096
  ds_read_b128 v[140:143], v14 offset:4352
  v_mfma_f32_16x16x32_bf16 v[224:227], v[80:83], v[72:75], v[224:227]
  ds_read_b128 v[144:147], v16 offset:0
  ds_read_b128 v[148:151], v16 offset:256
  v_mfma_f32_16x16x32_bf16 v[240:243], v[80:83], v[76:79], v[240:243]
  ds_read_b128 v[160:163], v14 offset:2048
  ds_read_b128 v[164:167], v14 offset:2304
  v_mfma_f32_16x16x32_bf16 v[196:199], v[84:87], v[64:67], v[196:199]
  ds_read_b128 v[168:171], v14 offset:6144
  ds_read_b128 v[172:175], v14 offset:6400
  v_mfma_f32_16x16x32_bf16 v[212:215], v[84:87], v[68:71], v[212:215]
  ds_read_b128 v[176:179], v16 offset:2048
  ds_read_b128 v[180:183], v16 offset:2304
  v_mfma_f32_16x16x32_bf16 v[228:231], v[84:87], v[72:75], v[228:231]
  s_add_u32 s23, s23, 16384
  s_cmp_eq_u32 s23, 65536
  v_mfma_f32_16x16x32_bf16 v[244:247], v[84:87], v[76:79], v[244:247]
  s_cselect_b32 s23, 0, s23
  s_add_u32 s59, s59, 16384
  v_mfma_f32_16x16x32_bf16 v[192:195], v[112:115], v[96:99], v[192:195]
  s_cmp_eq_u32 s59, 163840
  s_cselect_b32 s59, 65536, s59
  v_mfma_f32_16x16x32_bf16 v[208:211], v[112:115], v[100:103], v[208:211]
  v_add_u32 v14, s23, v6
  v_add_u32 v16, s59, v8
  v_mfma_f32_16x16x32_bf16 v[224:227], v[112:115], v[104:107], v[224:227]
  v_mfma_f32_16x16x32_bf16 v[240:243], v[112:115], v[108:111], v[240:243]
  v_mfma_f32_16x16x32_bf16 v[196:199], v[116:119], v[96:99], v[196:199]
  v_mfma_f32_16x16x32_bf16 v[212:215], v[116:119], v[100:103], v[212:215]
  v_mfma_f32_16x16x32_bf16 v[228:231], v[116:119], v[104:107], v[228:231]
  v_mfma_f32_16x16x32_bf16 v[244:247], v[116:119], v[108:111], v[244:247]
  s_waitcnt lgkmcnt(0)
  s_lshl_b32 s33, s20, 8
  s_add_u32 s33, s33, 98304
  v_lshlrev_b32 v56, 2, v4
  v_add_u32 v56, s33, v56
  v_mfma_f32_16x16x32_bf16 v[192:195], v[144:147], v[128:131], v[192:195]
  ds_read_b32 v52, v56 offset:0
  v_mfma_f32_16x16x32_bf16 v[208:211], v[144:147], v[132:135], v[208:211]
  ds_read_b32 v53, v56 offset:64
  v_mfma_f32_16x16x32_bf16 v[224:227], v[144:147], v[136:139], v[224:227]
  ds_read_b32 v54, v56 offset:128
  v_mfma_f32_16x16x32_bf16 v[240:243], v[144:147], v[140:143], v[240:243]
  ds_read_b32 v55, v56 offset:192
  v_mfma_f32_16x16x32_bf16 v[196:199], v[148:151], v[128:131], v[196:199]
  v_mfma_f32_16x16x32_bf16 v[212:215], v[148:151], v[132:135], v[212:215]
  v_mfma_f32_16x16x32_bf16 v[228:231], v[148:151], v[136:139], v[228:231]
  v_mfma_f32_16x16x32_bf16 v[244:247], v[148:151], v[140:143], v[244:247]
  v_mfma_f32_16x16x32_bf16 v[192:195], v[176:179], v[160:163], v[192:195]
  v_mfma_f32_16x16x32_bf16 v[208:211], v[176:179], v[164:167], v[208:211]
  v_mfma_f32_16x16x32_bf16 v[224:227], v[176:179], v[168:171], v[224:227]
  v_mfma_f32_16x16x32_bf16 v[240:243], v[176:179], v[172:175], v[240:243]
  v_mfma_f32_16x16x32_bf16 v[196:199], v[180:183], v[160:163], v[196:199]
  v_mfma_f32_16x16x32_bf16 v[212:215], v[180:183], v[164:167], v[212:215]
  v_mfma_f32_16x16x32_bf16 v[228:231], v[180:183], v[168:171], v[228:231]
  v_mfma_f32_16x16x32_bf16 v[244:247], v[180:183], v[172:175], v[244:247]
  v_lshlrev_b32 v64, 16, v20
  v_and_b32 v65, 0xffff0000, v20
  v_lshlrev_b32 v66, 16, v21
  v_and_b32 v67, 0xffff0000, v21
  v_lshlrev_b32 v68, 16, v22
  v_and_b32 v69, 0xffff0000, v22
  v_lshlrev_b32 v70, 16, v23
  v_and_b32 v71, 0xffff0000, v23
  v_lshlrev_b32 v72, 16, v24
  v_and_b32 v73, 0xffff0000, v24
  v_lshlrev_b32 v74, 16, v25
  v_and_b32 v75, 0xffff0000, v25
  v_lshlrev_b32 v76, 16, v26
  v_and_b32 v77, 0xffff0000, v26
  v_lshlrev_b32 v78, 16, v27
  v_and_b32 v79, 0xffff0000, v27
  v_lshlrev_b32 v80, 16, v28
  v_and_b32 v81, 0xffff0000, v28
  v_lshlrev_b32 v82, 16, v29
  v_and_b32 v83, 0xffff0000, v29
  v_lshlrev_b32 v84, 16, v30
  v_and_b32 v85, 0xffff0000, v30
  v_lshlrev_b32 v86, 16, v31
  v_and_b32 v87, 0xffff0000, v31
  v_lshlrev_b32 v88, 16, v32
  v_and_b32 v89, 0xffff0000, v32
  v_lshlrev_b32 v90, 16, v33
  v_and_b32 v91, 0xffff0000, v33
  v_lshlrev_b32 v92, 16, v34
  v_and_b32 v93, 0xffff0000, v34
  v_lshlrev_b32 v94, 16, v35
  v_and_b32 v95, 0xffff0000, v35
  s_waitcnt vmcnt(3)
  v_lshlrev_b32 v96, 16, v200
  v_and_b32 v97, 0xffff0000, v200
  v_lshlrev_b32 v98, 16, v201
  v_and_b32 v99, 0xffff0000, v201
  v_lshlrev_b32 v100, 16, v202
  v_and_b32 v101, 0xffff0000, v202
  v_lshlrev_b32 v102, 16, v203
  v_and_b32 v103, 0xffff0000, v203
  v_add_f32 v192, v192, v96
  v_add_f32 v193, v193, v97
  v_add_f32 v194, v194, v98
  v_add_f32 v195, v195, v99
  v_add_f32 v196, v196, v100
  v_add_f32 v197, v197, v101
  v_add_f32 v198, v198, v102
  v_add_f32 v199, v199, v103
  v_mul_f32 v192, v192, v52
  v_mul_f32 v193, v193, v52
  v_mul_f32 v194, v194, v52
  v_mul_f32 v195, v195, v52
  v_mul_f32 v196, v196, v52
  v_mul_f32 v197, v197, v52
  v_mul_f32 v198, v198, v52
  v_mul_f32 v199, v199, v52
  v_fmac_f32 v64, v192, v36
  v_fmac_f32 v65, v193, v37
  v_fmac_f32 v66, v194, v38
  v_fmac_f32 v67, v195, v39
  v_fmac_f32 v68, v196, v40
  v_fmac_f32 v69, v197, v41
  v_fmac_f32 v70, v198, v42
  v_fmac_f32 v71, v199, v43
  v_cvt_pk_bf16_f32 v192, v64, v65
  v_cvt_pk_bf16_f32 v193, v66, v67
  v_cvt_pk_bf16_f32 v194, v68, v69
  v_cvt_pk_bf16_f32 v195, v70, v71
  buffer_store_dwordx4 v[192:195], v18, s[12:15], s30 offen sc1
  s_add_u32 s30, s30, 32768
  s_waitcnt vmcnt(3)
  v_lshlrev_b32 v96, 16, v216
  v_and_b32 v97, 0xffff0000, v216
  v_lshlrev_b32 v98, 16, v217
  v_and_b32 v99, 0xffff0000, v217
  v_lshlrev_b32 v100, 16, v218
  v_and_b32 v101, 0xffff0000, v218
  v_lshlrev_b32 v102, 16, v219
  v_and_b32 v103, 0xffff0000, v219
  v_add_f32 v208, v208, v96
  v_add_f32 v209, v209, v97
  v_add_f32 v210, v210, v98
  v_add_f32 v211, v211, v99
  v_add_f32 v212, v212, v100
  v_add_f32 v213, v213, v101
  v_add_f32 v214, v214, v102
  v_add_f32 v215, v215, v103
  v_mul_f32 v208, v208, v53
  v_mul_f32 v209, v209, v53
  v_mul_f32 v210, v210, v53
  v_mul_f32 v211, v211, v53
  v_mul_f32 v212, v212, v53
  v_mul_f32 v213, v213, v53
  v_mul_f32 v214, v214, v53
  v_mul_f32 v215, v215, v53
  v_fmac_f32 v72, v208, v36
  v_fmac_f32 v73, v209, v37
  v_fmac_f32 v74, v210, v38
  v_fmac_f32 v75, v211, v39
  v_fmac_f32 v76, v212, v40
  v_fmac_f32 v77, v213, v41
  v_fmac_f32 v78, v214, v42
  v_fmac_f32 v79, v215, v43
  v_cvt_pk_bf16_f32 v208, v72, v73
  v_cvt_pk_bf16_f32 v209, v74, v75
  v_cvt_pk_bf16_f32 v210, v76, v77
  v_cvt_pk_bf16_f32 v211, v78, v79
  buffer_store_dwordx4 v[208:211], v18, s[12:15], s30 offen sc1
  s_add_u32 s30, s30, 32768
  s_waitcnt vmcnt(3)
  v_lshlrev_b32 v96, 16, v232
  v_and_b32 v97, 0xffff0000, v232
  v_lshlrev_b32 v98, 16, v233
  v_and_b32 v99, 0xffff0000, v233
  v_lshlrev_b32 v100, 16, v234
  v_and_b32 v101, 0xffff0000, v234
  v_lshlrev_b32 v102, 16, v235
  v_and_b32 v103, 0xffff0000, v235
  v_add_f32 v224, v224, v96
  v_add_f32 v225, v225, v97
  v_add_f32 v226, v226, v98
  v_add_f32 v227, v227, v99
  v_add_f32 v228, v228, v100
  v_add_f32 v229, v229, v101
  v_add_f32 v230, v230, v102
  v_add_f32 v231, v231, v103
  v_mul_f32 v224, v224, v54
  v_mul_f32 v225, v225, v54
  v_mul_f32 v226, v226, v54
  v_mul_f32 v227, v227, v54
  v_mul_f32 v228, v228, v54
  v_mul_f32 v229, v229, v54
  v_mul_f32 v230, v230, v54
  v_mul_f32 v231, v231, v54
  v_fmac_f32 v80, v224, v36
  v_fmac_f32 v81, v225, v37
  v_fmac_f32 v82, v226, v38
  v_fmac_f32 v83, v227, v39
  v_fmac_f32 v84, v228, v40
  v_fmac_f32 v85, v229, v41
  v_fmac_f32 v86, v230, v42
  v_fmac_f32 v87, v231, v43
  v_cvt_pk_bf16_f32 v224, v80, v81
  v_cvt_pk_bf16_f32 v225, v82, v83
  v_cvt_pk_bf16_f32 v226, v84, v85
  v_cvt_pk_bf16_f32 v227, v86, v87
  buffer_store_dwordx4 v[224:227], v18, s[12:15], s30 offen sc1
  s_add_u32 s30, s30, 32768
  s_waitcnt vmcnt(3)
  v_lshlrev_b32 v96, 16, v248
  v_and_b32 v97, 0xffff0000, v248
  v_lshlrev_b32 v98, 16, v249
  v_and_b32 v99, 0xffff0000, v249
  v_lshlrev_b32 v100, 16, v250
  v_and_b32 v101, 0xffff0000, v250
  v_lshlrev_b32 v102, 16, v251
  v_and_b32 v103, 0xffff0000, v251
  v_add_f32 v240, v240, v96
  v_add_f32 v241, v241, v97
  v_add_f32 v242, v242, v98
  v_add_f32 v243, v243, v99
  v_add_f32 v244, v244, v100
  v_add_f32 v245, v245, v101
  v_add_f32 v246, v246, v102
  v_add_f32 v247, v247, v103
  v_mul_f32 v240, v240, v55
  v_mul_f32 v241, v241, v55
  v_mul_f32 v242, v242, v55
  v_mul_f32 v243, v243, v55
  v_mul_f32 v244, v244, v55
  v_mul_f32 v245, v245, v55
  v_mul_f32 v246, v246, v55
  v_mul_f32 v247, v247, v55
  v_fmac_f32 v88, v240, v36
  v_fmac_f32 v89, v241, v37
  v_fmac_f32 v90, v242, v38
  v_fmac_f32 v91, v243, v39
  v_fmac_f32 v92, v244, v40
  v_fmac_f32 v93, v245, v41
  v_fmac_f32 v94, v246, v42
  v_fmac_f32 v95, v247, v43
  v_cvt_pk_bf16_f32 v240, v88, v89
  v_cvt_pk_bf16_f32 v241, v90, v91
  v_cvt_pk_bf16_f32 v242, v92, v93
  v_cvt_pk_bf16_f32 v243, v94, v95
  buffer_store_dwordx4 v[240:243], v18, s[12:15], s30 offen sc1
  s_endpgm
L_adaL_woC_hook:
  s_lshl_b32 s31, s28, 7
  s_add_u32 s32, s31, 8192
  s_add_u32 s33, s31, 16384
  buffer_load_dwordx4 v[36:39], v19, s[8:11], s32 offen offset:0 sc1
  buffer_load_dwordx4 v[44:47], v19, s[8:11], s33 offen offset:0 sc1
  buffer_load_dwordx4 v[40:43], v19, s[8:11], s32 offen offset:16 sc1
  buffer_load_dwordx4 v[48:51], v19, s[8:11], s33 offen offset:16 sc1
  s_branch L_adaL_woC_hookr
L_adaL_ffn1C_hook:
  s_mov_b64 exec, 1
  s_waitcnt vmcnt(0)
  buffer_atomic_add v13, v12, s[8:11], s55 offen sc1
  s_mov_b64 exec, -1
  s_branch L_adaL_ffn1C_hookr
L_adaL_ffn2C_hook:
  s_lshl_b32 s31, s28, 7
  s_add_u32 s32, s31, 20480
  buffer_load_dwordx4 v[36:39], v19, s[8:11], s32 offen offset:0 sc1
  buffer_load_dwordx4 v[40:43], v19, s[8:11], s32 offen offset:16 sc1
  s_branch L_adaL_ffn2C_hookr
L_adaL_roleL:
  s_and_b32 s16, s2, 7
  s_lshr_b32 s17, s2, 3
  s_and_b32 s18, s16, 1
  s_lshl_b32 s18, s18, 3
  s_and_b32 s19, s17, 7
  s_add_u32 s18, s18, s19
  s_lshr_b32 s19, s16, 1
  s_lshl_b32 s19, s19, 2
  s_lshr_b32 s17, s17, 3
  s_add_u32 s19, s19, s17
  s_lshl_b32 s21, s18, 2
  s_add_u32 s21, s21, s3
  s_mul_i32 s21, s21, 66560
  s_add_u32 s21, s21, 1048576
  v_add_u32 v3, s21, v2
  v_lshrrev_b32 v4, 3, v0
  v_and_b32 v5, 2, v4
  v_and_b32 v6, 7, v0
  v_xor_b32 v5, v5, v6
  v_lshlrev_b32 v5, 4, v5
  v_mul_u32_u24 v4, 6144, v4
  s_lshl_b32 s23, s19, 7
  s_mul_i32 s24, s3, 49152
  s_add_u32 s23, s23, s24
  s_and_b32 s24, s3, 1
  s_lshl_b32 s24, s24, 6
  v_xor_b32 v5, s24, v5
  v_add3_u32 v8, v4, v5, s23
  v_add_u32 v9, 2048, v8
  v_add_u32 v10, 4096, v8
  s_mul_i32 s25, s3, 2048
  s_mul_i32 s26, s3, 1024
  s_add_u32 s26, s26, 8192
  s_mov_b32 s28, 0
  s_mov_b32 s29, 0
  s_mov_b32 s12, s66
  s_and_b32 s13, s67, 0xffff
  s_mov_b32 s14, 6291456
  s_mov_b32 s15, 0x20000
L_adaL_qkvL_v0:
  s_mov_b32 s27, 0
  s_mov_b32 s31, 0
L_adaL_qkvL_pw0:
  s_add_u32 s30, s27, s26
  s_add_u32 m0, s30, 0
  s_nop 0
  buffer_load_dwordx4 v8, s[12:15], s29 offen lds
  s_add_u32 m0, s30, 4096
  s_nop 0
  buffer_load_dwordx4 v9, s[12:15], s29 offen lds
  s_add_u32 m0, s30, 8192
  s_nop 0
  buffer_load_dwordx4 v10, s[12:15], s29 offen lds
  s_add_u32 s29, s29, 196608
  s_add_u32 s27, s27, 20480
  s_add_u32 s31, s31, 1
  s_cmp_lt_u32 s31, 7
  s_cbranch_scc1 L_adaL_qkvL_pw0
  s_cmp_lg_u32 s3, 0
  s_cbranch_scc1 L_adaL_qkvL_hb
  s_lshl_b32 s40, s18, 7
  s_add_u32 s40, s40, 466944
  v_lshlrev_b32 v56, 7, v0
  s_mov_b32 s62, 0
  s_mov_b64 exec, 1
L_adaL_qkvL_px:
  v_mov_b32 v57, 0
  buffer_atomic_add v57, v56, s[8:11], s40 offen sc0 sc1
  s_add_u32 s62, s62, 1
  s_cmp_gt_u32 s62, 0x80000
  s_cbranch_scc1 L_adaL_qkvL_pxx
  s_waitcnt vmcnt(0)
  v_cmp_gt_u32 vcc, 64, v57
  s_nop 3
  s_cbranch_vccz L_adaL_qkvL_pxx
  s_sleep 2
  s_branch L_adaL_qkvL_px
L_adaL_qkvL_pxx:
  s_mov_b64 exec, -1
L_adaL_qkvL_hb:
  s_barrier
  s_mov_b32 s27, 0
  s_mov_b32 s31, 0
L_adaL_qkvL_px0_:
  s_add_u32 m0, s27, s25
  s_nop 0
  buffer_load_dwordx4 v3, s[8:11], s28 offen offset:0 sc1 lds
  buffer_load_dwordx4 v3, s[8:11], s28 offen offset:1024 sc1 lds
  s_add_u32 s28, s28, 2048
  s_add_u32 s27, s27, 20480
  s_add_u32 s31, s31, 1
  s_cmp_lt_u32 s31, 7
  s_cbranch_scc1 L_adaL_qkvL_px0_
L_adaL_qkvL_lloop0:
  s_cmp_lt_u32 s31, 13
  s_cbranch_scc1 L_adaL_qkvL_early0
  s_waitcnt vmcnt(30)
L_adaL_qkvL_lbar0:
  s_barrier
  s_add_u32 m0, s27, s25
  s_nop 0
  buffer_load_dwordx4 v3, s[8:11], s28 offen offset:0 sc1 lds
  buffer_load_dwordx4 v3, s[8:11], s28 offen offset:1024 sc1 lds
  s_add_u32 s28, s28, 2048
  s_add_u32 s30, s27, s26
  s_add_u32 m0, s30, 0
  s_nop 0
  buffer_load_dwordx4 v8, s[12:15], s29 offen lds
  s_add_u32 m0, s30, 4096
  s_nop 0
  buffer_load_dwordx4 v9, s[12:15], s29 offen lds
  s_add_u32 m0, s30, 8192
  s_nop 0
  buffer_load_dwordx4 v10, s[12:15], s29 offen lds
  s_add_u32 s29, s29, 196608
  s_add_u32 s27, s27, 20480
  s_cmp_eq_u32 s27, 163840
  s_cselect_b32 s27, 0, s27
  s_add_u32 s31, s31, 1
  s_cmp_lt_u32 s31, 32
  s_cbranch_scc1 L_adaL_qkvL_lloop0
  s_getpc_b64 s[60:61]
L_adaL_qkvL_pc4806:
  s_add_u32 s60, s60, adaLN_cond__softmax_full_mha__dense_activation_relu__prompt_kernel-L_adaL_qkvL_pc4806
  s_addc_u32 s61, s61, -1
  s_lshr_b32 s62, s2, 3
  s_lshl_b32 s62, s62, 11
  v_and_b32 v54, 15, v0
  v_lshlrev_b32 v54, 7, v54
  v_add_u32 v54, s62, v54
  v_min_u32 v54, adaLN_cond__softmax_full_mha__dense_activation_relu__prompt_kernel_end-adaLN_cond__softmax_full_mha__dense_activation_relu__prompt_kernel-4, v54
  v_mov_b32 v55, s61
  v_add_co_u32 v54, vcc, s60, v54
  s_nop 1
  v_addc_co_u32 v55, vcc, 0, v55, vcc
  global_load_dword v56, v[54:55], off
  s_waitcnt vmcnt(31)
  s_barrier
  s_waitcnt vmcnt(26)
  s_barrier
  s_waitcnt vmcnt(21)
  s_barrier
  s_waitcnt vmcnt(16)
  s_barrier
  s_waitcnt vmcnt(11)
  s_barrier
  s_waitcnt vmcnt(6)
  s_barrier
  s_waitcnt vmcnt(1)
  s_barrier
L_adaL_qkvL_done:
  s_barrier
L_adaL_qkvL_done2:
  s_and_b32 s16, s2, 7
  s_lshr_b32 s17, s2, 3
  s_and_b32 s18, s16, 1
  s_lshl_b32 s18, s18, 3
  s_and_b32 s19, s17, 7
  s_add_u32 s18, s18, s19
  s_lshr_b32 s19, s16, 1
  s_lshl_b32 s19, s19, 2
  s_lshr_b32 s17, s17, 3
  s_add_u32 s19, s19, s17
  s_lshr_b32 s17, s2, 3
  v_mov_b32 v3, 163712
  s_cmp_lg_u32 s3, 0
  s_cbranch_scc1 L_adaL_atL_service
  s_lshl_b32 s54, s19, 7
  s_add_u32 s54, s54, 395328
  s_lshl_b32 s40, s19, 8
  s_add_u32 s40, s40, 397312
  s_lshr_b32 s41, s18, 3
  s_lshl_b32 s42, s41, 7
  s_add_u32 s40, s40, s42
  s_xor_b32 s43, s40, 128
  s_mov_b32 s24, 0
  s_lshl_b32 s44, s19, 19
  s_add_u32 s44, s44, 9568256
  v_add_u32 v8, 0x40000, v2
  v_and_b32 v9, 31, v0
  v_lshlrev_b32 v9, 2, v9
  v_add_u32 v9, v9, v3
  v_mov_b32 v10, 0
  ds_write_b32 v9, v10
  s_mov_b32 s25, 1
  s_waitcnt lgkmcnt(0)
  s_barrier
  v_lshlrev_b32 v56, 7, v0
  s_mov_b32 s62, 0
  s_mov_b64 exec, 1
L_adaL_atL_px:
  v_mov_b32 v57, 0
  buffer_atomic_add v57, v56, s[8:11], s40 offen sc0 sc1
  s_add_u32 s62, s62, 1
  s_cmp_gt_u32 s62, 0x80000
  s_cbranch_scc1 L_adaL_atL_pxx
  s_waitcnt vmcnt(0)
  v_cmp_gt_u32 vcc, 32, v57
  s_nop 3
  s_cbranch_vccz L_adaL_atL_pxx
  s_sleep 2
  s_branch L_adaL_atL_px
L_adaL_atL_pxx:
  s_mov_b64 exec, -1
L_adaL_atL_lloop:
  s_cmp_lt_u32 s25, 4
  s_cbranch_scc1 L_adaL_atL_free
  s_sub_u32 s22, s25, 3
  ds_read_b128 v[12:15], v3
  s_waitcnt lgkmcnt(0)
  v_min3_u32 v12, v12, v13, v14
  v_min_u32 v12, v12, v15
  v_mov_b32 v10, s25
  v_readfirstlane_b32 s63, v12
  s_nop 0
  s_cmp_ge_u32 s63, s22
  s_cbranch_scc1 L_adaL_atL_free
  s_waitcnt vmcnt(0)
  ds_write_b32 v3, v10 offset:16
  s_mov_b32 s62, 0
L_adaL_atL_wf:
  ds_read_b128 v[12:15], v3 offset:0
  s_add_u32 s62, s62, 1
  s_waitcnt lgkmcnt(0)
  v_min3_u32 v12, v12, v13, v14
  v_min_u32 v12, v12, v15
  s_cmp_gt_u32 s62, 0x1000000
  v_readfirstlane_b32 s63, v12
  s_cbranch_scc1 L_adaL_atL_wfx
  s_cmp_ge_u32 s63, s22
  s_cbranch_scc1 L_adaL_atL_wfx
  s_sleep 2
  s_branch L_adaL_atL_wf
L_adaL_atL_wfx:
L_adaL_atL_free:
  s_add_u32 s20, s18, s25
  s_and_b32 s20, s20, 7
  s_xor_b32 s21, s18, s25
  s_and_b32 s21, s21, 8
  s_or_b32 s20, s20, s21
  s_lshl_b32 s20, s20, 14
  s_add_u32 s20, s20, s44
  s_and_b32 s21, s25, 3
  s_lshl_b32 s21, s21, 14
  s_add_u32 m0, s21, 0
  s_nop 0
  buffer_load_dwordx4 v2, s[8:11], s20 offen offset:0 sc1 lds
  buffer_load_dwordx4 v2, s[8:11], s20 offen offset:1024 sc1 lds
  buffer_load_dwordx4 v2, s[8:11], s20 offen offset:2048 sc1 lds
  buffer_load_dwordx4 v2, s[8:11], s20 offen offset:3072 sc1 lds
  s_add_u32 m0, s21, 65536
  s_nop 0
  buffer_load_dwordx4 v8, s[8:11], s20 offen offset:0 sc1 lds
  buffer_load_dwordx4 v8, s[8:11], s20 offen offset:1024 sc1 lds
  buffer_load_dwordx4 v8, s[8:11], s20 offen offset:2048 sc1 lds
  buffer_load_dwordx4 v8, s[8:11], s20 offen offset:3072 sc1 lds
  s_add_u32 s20, s20, 4096
  s_add_u32 m0, s21, 4096
  s_nop 0
  buffer_load_dwordx4 v2, s[8:11], s20 offen offset:0 sc1 lds
  buffer_load_dwordx4 v2, s[8:11], s20 offen offset:1024 sc1 lds
  buffer_load_dwordx4 v2, s[8:11], s20 offen offset:2048 sc1 lds
  buffer_load_dwordx4 v2, s[8:11], s20 offen offset:3072 sc1 lds
  s_add_u32 m0, s21, 69632
  s_nop 0
  buffer_load_dwordx4 v8, s[8:11], s20 offen offset:0 sc1 lds
  buffer_load_dwordx4 v8, s[8:11], s20 offen offset:1024 sc1 lds
  buffer_load_dwordx4 v8, s[8:11], s20 offen offset:2048 sc1 lds
  buffer_load_dwordx4 v8, s[8:11], s20 offen offset:3072 sc1 lds
  s_add_u32 s20, s20, 4096
  s_add_u32 m0, s21, 8192
  s_nop 0
  buffer_load_dwordx4 v2, s[8:11], s20 offen offset:0 sc1 lds
  buffer_load_dwordx4 v2, s[8:11], s20 offen offset:1024 sc1 lds
  buffer_load_dwordx4 v2, s[8:11], s20 offen offset:2048 sc1 lds
  buffer_load_dwordx4 v2, s[8:11], s20 offen offset:3072 sc1 lds
  s_add_u32 m0, s21, 73728
  s_nop 0
  buffer_load_dwordx4 v8, s[8:11], s20 offen offset:0 sc1 lds
  buffer_load_dwordx4 v8, s[8:11], s20 offen offset:1024 sc1 lds
  buffer_load_dwordx4 v8, s[8:11], s20 offen offset:2048 sc1 lds
  buffer_load_dwordx4 v8, s[8:11], s20 offen offset:3072 sc1 lds
  s_add_u32 s20, s20, 4096
  s_add_u32 m0, s21, 12288
  s_nop 0
  buffer_load_dwordx4 v2, s[8:11], s20 offen offset:0 sc1 lds
  buffer_load_dwordx4 v2, s[8:11], s20 offen offset:1024 sc1 lds
  buffer_load_dwordx4 v2, s[8:11], s20 offen offset:2048 sc1 lds
  buffer_load_dwordx4 v2, s[8:11], s20 offen offset:3072 sc1 lds
  s_add_u32 m0, s21, 77824
  s_nop 0
  buffer_load_dwordx4 v8, s[8:11], s20 offen offset:0 sc1 lds
  buffer_load_dwordx4 v8, s[8:11], s20 offen offset:1024 sc1 lds
  buffer_load_dwordx4 v8, s[8:11], s20 offen offset:2048 sc1 lds
  buffer_load_dwordx4 v8, s[8:11], s20 offen offset:3072 sc1 lds
  s_add_u32 s20, s20, 4096
  v_mov_b32 v10, s25
  s_add_u32 s25, s25, 1
  s_waitcnt vmcnt(32)
  ds_write_b32 v3, v10 offset:16
  s_cmp_lg_u32 s25, 4
  s_cbranch_scc1 L_adaL_atL_nochk
  v_lshlrev_b32 v56, 7, v0
  s_mov_b32 s62, 0
  s_mov_b64 exec, 1
L_adaL_atL_p2:
  v_mov_b32 v57, 0
  buffer_atomic_add v57, v56, s[8:11], s43 offen sc0 sc1
  s_add_u32 s62, s62, 1
  s_cmp_gt_u32 s62, 0x80000
  s_cbranch_scc1 L_adaL_atL_p2x
  s_waitcnt vmcnt(0)
  v_cmp_gt_u32 vcc, 32, v57
  s_nop 3
  s_cbranch_vccz L_adaL_atL_p2x
  s_sleep 2
  s_branch L_adaL_atL_p2
L_adaL_atL_p2x:
  s_mov_b64 exec, -1
  s_xor_b32 s20, s18, 8
  s_lshl_b32 s20, s20, 14
  s_add_u32 s20, s20, s44
  v_lshlrev_b32 v11, 7, v0
  buffer_load_dword v16, v11, s[8:11], s20 offen sc1
  s_add_u32 s20, s20, 8192
  buffer_load_dword v16, v11, s[8:11], s20 offen sc1
  s_add_u32 s20, s20, 253952
  buffer_load_dword v16, v11, s[8:11], s20 offen sc1
  s_add_u32 s20, s20, 8192
  buffer_load_dword v16, v11, s[8:11], s20 offen sc1
  s_add_u32 s20, s20, 8192
L_adaL_atL_nochk:
  s_cmp_lt_u32 s25, 16
  s_cbranch_scc1 L_adaL_atL_lloop
  v_mov_b32 v10, 16
  s_waitcnt vmcnt(0)
  ds_write_b32 v3, v10 offset:16
  v_lshlrev_b32 v56, 7, v0
  s_mov_b32 s62, 0
  s_mov_b64 exec, 1
L_adaL_atL_pp0:
  v_mov_b32 v57, 0
  buffer_atomic_add v57, v56, s[8:11], s54 offen sc0 sc1
  s_add_u32 s62, s62, 1
  s_cmp_gt_u32 s62, 0x80000
  s_cbranch_scc1 L_adaL_atL_pp0x
  s_waitcnt vmcnt(0)
  v_cmp_gt_u32 vcc, 4, v57
  s_nop 3
  s_cbranch_vccz L_adaL_atL_pp0x
  s_sleep 2
  s_branch L_adaL_atL_pp0
L_adaL_atL_pp0x:
  s_mov_b64 exec, -1
  s_waitcnt lgkmcnt(0)
  s_barrier
  s_add_u32 s24, s24, 1
  s_cmp_eq_u32 s24, 3
  s_cbranch_scc1 L_adaL_atL_done
  ds_read_b128 v[4:7], v3 offset:32
  s_waitcnt lgkmcnt(0)
  v_or3_b32 v4, v4, v5, v6
  v_or_b32 v4, v4, v7
  s_nop 0
  v_readfirstlane_b32 s26, v4
  s_nop 0
  s_cmp_eq_u32 s26, 0
  s_cbranch_scc1 L_adaL_atL_done
  v_mov_b32 v12, 0
  v_mov_b32 v13, 0
  v_mov_b32 v14, 0
  v_mov_b32 v15, 0
  ds_write_b128 v3, v[12:15]
  ds_write_b32 v3, v12 offset:16
  s_mov_b32 s25, 0
  s_waitcnt lgkmcnt(0)
  s_barrier
  s_branch L_adaL_atL_lloop
L_adaL_atL_service:
  s_cmp_eq_u32 s3, 3
  s_cbranch_scc1 L_adaL_atL_modw
  s_sub_u32 s30, s3, 1
  s_cmp_lt_u32 s2, 112
  s_cbranch_scc0 L_adaL_atL_pw2
  s_lshr_b32 s32, s2, 1
  s_and_b32 s33, s2, 1
  s_mov_b32 s44, 66560
  s_mov_b32 s43, 30932992
  s_movk_i32 s46, 7168
  s_mov_b32 s12, s72
  s_and_b32 s13, s73, 0xffff
  s_mov_b32 s14, 7340032
  s_mov_b32 s15, 0x20000
  s_mul_i32 s34, s32, 9363
  s_lshr_b32 s34, s34, 16
  s_mul_i32 s34, s34, 7
  s_sub_u32 s34, s32, s34
  s_branch L_adaL_atL_pgo
L_adaL_atL_pw2:
  s_mov_b32 s34, 0
  s_movk_i32 s32, 224
  s_mov_b32 s44, 66560
  s_mov_b32 s43, 38535168
  s_mov_b32 s14, 2097152
  s_cmp_lt_u32 s2, 224
  s_cselect_b32 s32, 112, s32
  s_cselect_b32 s44, 230400, s44
  s_cselect_b32 s43, 40763392, s43
  s_cselect_b32 s12, s74, s68
  s_cselect_b32 s13, s75, s69
  s_cselect_b32 s14, 7340032, s14
  s_and_b32 s13, s13, 0xffff
  s_mov_b32 s15, 0x20000
  s_sub_u32 s32, s2, s32
  s_lshr_b32 s33, s32, 4
  s_and_b32 s32, s32, 15
  s_movk_i32 s46, 2048
L_adaL_atL_pgo:
  s_lshl_b32 s33, s33, 1
  s_add_u32 s33, s33, s30
  s_mul_i32 s40, s33, s46
  s_lshl_b32 s40, s40, 8
  s_lshl_b32 s35, s32, 7
  s_add_u32 s40, s40, s35
  s_lshl_b32 s35, s32, 1
  s_mul_i32 s35, s35, s44
  s_add_u32 s43, s43, s35
  s_lshl_b32 s35, s33, 3
  v_add_u32 v9, s35, v0
  v_lshlrev_b32 v9, 11, v9
  v_add_u32 v9, s43, v9
  v_lshrrev_b32 v12, 3, v0
  v_and_b32 v14, 7, v0
  v_lshlrev_b32 v14, 4, v14
  v_mad_u32_u24 v12, v12, s46, v14
  s_lshl_b32 s41, s46, 3
  s_mul_i32 s42, s30, 12288
  s_add_u32 s42, s42, 131072
  v_lshrrev_b32 v14, 5, v0
  v_lshlrev_b32 v15, 10, v14
  v_bfe_u32 v14, v0, 2, 2
  v_lshl_add_u32 v15, v14, 7, v15
  v_add_u32 v15, s42, v15
  v_and_b32 v10, 3, v0
  v_bfe_u32 v11, v0, 4, 1
  s_cmp_eq_u32 s34, 5
  s_cselect_b32 s48, 3, 4
  s_cselect_b32 s49, 5, 3
  v_lshl_add_u32 v13, v10, s48, v15
  v_lshl_add_u32 v13, v11, s49, v13
  s_cmp_eq_u32 s34, 1
  s_cselect_b32 s48, 3, 4
  s_cselect_b32 s49, 5, 3
  v_lshl_add_u32 v14, v10, s48, v15
  v_lshl_add_u32 v14, v11, s49, v14
  v_add_u32 v14, 64, v14
  s_barrier
  s_mul_i32 s47, s17, 43
  s_lshr_b32 s47, s47, 7
  s_mul_i32 s47, s47, 3
  s_sub_u32 s47, s17, s47
  s_add_u32 s47, s47, 6
  s_mov_b32 s62, 0
L_adaL_atL_pa0:
  ds_read_b32 v4, v3 offset:16
  s_add_u32 s62, s62, 1
  s_waitcnt lgkmcnt(0)
  s_cmp_gt_u32 s62, 0x1000000
  v_readfirstlane_b32 s63, v4
  s_cbranch_scc1 L_adaL_atL_pa0x
  s_cmp_ge_u32 s63, s47
  s_cbranch_scc1 L_adaL_atL_pa0x
  s_sleep 8
  s_branch L_adaL_atL_pa0
L_adaL_atL_pa0x:
  s_add_u32 s47, s47, 3
  s_mov_b32 m0, s42
  s_add_u32 s42, s42, 1024
  buffer_load_dwordx4 v12, s[12:15], s40 offen lds
  s_add_u32 s40, s40, s41
  s_mov_b32 m0, s42
  s_add_u32 s42, s42, 1024
  buffer_load_dwordx4 v12, s[12:15], s40 offen lds
  s_add_u32 s40, s40, s41
  s_mov_b32 m0, s42
  s_add_u32 s42, s42, 1024
  buffer_load_dwordx4 v12, s[12:15], s40 offen lds
  s_add_u32 s40, s40, s41
  s_mov_b32 m0, s42
  s_add_u32 s42, s42, 1024
  buffer_load_dwordx4 v12, s[12:15], s40 offen lds
  s_add_u32 s40, s40, s41
  s_mov_b32 m0, s42
  s_add_u32 s42, s42, 1024
  buffer_load_dwordx4 v12, s[12:15], s40 offen lds
  s_add_u32 s40, s40, s41
  s_mov_b32 m0, s42
  s_add_u32 s42, s42, 1024
  buffer_load_dwordx4 v12, s[12:15], s40 offen lds
  s_add_u32 s40, s40, s41
  s_mov_b32 m0, s42
  s_add_u32 s42, s42, 1024
  buffer_load_dwordx4 v12, s[12:15], s40 offen lds
  s_add_u32 s40, s40, s41
  s_mov_b32 m0, s42
  s_add_u32 s42, s42, 1024
  buffer_load_dwordx4 v12, s[12:15], s40 offen lds
  s_add_u32 s40, s40, s41
  s_mov_b32 m0, s42
  s_add_u32 s42, s42, 1024
  buffer_load_dwordx4 v12, s[12:15], s40 offen lds
  s_add_u32 s40, s40, s41
  s_mov_b32 m0, s42
  s_add_u32 s42, s42, 1024
  buffer_load_dwordx4 v12, s[12:15], s40 offen lds
  s_add_u32 s40, s40, s41
  s_mov_b32 m0, s42
  s_add_u32 s42, s42, 1024
  buffer_load_dwordx4 v12, s[12:15], s40 offen lds
  s_add_u32 s40, s40, s41
  s_mov_b32 m0, s42
  s_add_u32 s42, s42, 1024
  buffer_load_dwordx4 v12, s[12:15], s40 offen lds
  s_add_u32 s40, s40, s41
  s_waitcnt vmcnt(8)
  v_readlane_b32 s43, v9, 0
  ds_read_b64_tr_b16 v[16:17], v13 offset:0
  ds_read_b64_tr_b16 v[18:19], v13 offset:512
  ds_read_b64_tr_b16 v[20:21], v14 offset:0
  ds_read_b64_tr_b16 v[22:23], v14 offset:512
  ds_read_b64_tr_b16 v[24:25], v13 offset:2048
  ds_read_b64_tr_b16 v[26:27], v13 offset:2560
  ds_read_b64_tr_b16 v[28:29], v14 offset:2048
  ds_read_b64_tr_b16 v[30:31], v14 offset:2560
  s_add_u32 s45, s43, s44
  s_waitcnt lgkmcnt(6)
  buffer_store_dwordx4 v[16:19], v2, s[8:11], s43 offen offset:0 sc1
  s_waitcnt lgkmcnt(4)
  buffer_store_dwordx4 v[20:23], v2, s[8:11], s45 offen offset:0 sc1
  s_waitcnt lgkmcnt(2)
  buffer_store_dwordx4 v[24:27], v2, s[8:11], s43 offen offset:1024 sc1
  s_waitcnt lgkmcnt(0)
  buffer_store_dwordx4 v[28:31], v2, s[8:11], s45 offen offset:1024 sc1
  s_waitcnt vmcnt(8)
  v_readlane_b32 s43, v9, 1
  ds_read_b64_tr_b16 v[32:33], v13 offset:4096
  ds_read_b64_tr_b16 v[34:35], v13 offset:4608
  ds_read_b64_tr_b16 v[36:37], v14 offset:4096
  ds_read_b64_tr_b16 v[38:39], v14 offset:4608
  ds_read_b64_tr_b16 v[40:41], v13 offset:6144
  ds_read_b64_tr_b16 v[42:43], v13 offset:6656
  ds_read_b64_tr_b16 v[44:45], v14 offset:6144
  ds_read_b64_tr_b16 v[46:47], v14 offset:6656
  s_add_u32 s45, s43, s44
  s_waitcnt lgkmcnt(6)
  buffer_store_dwordx4 v[32:35], v2, s[8:11], s43 offen offset:0 sc1
  s_waitcnt lgkmcnt(4)
  buffer_store_dwordx4 v[36:39], v2, s[8:11], s45 offen offset:0 sc1
  s_waitcnt lgkmcnt(2)
  buffer_store_dwordx4 v[40:43], v2, s[8:11], s43 offen offset:1024 sc1
  s_waitcnt lgkmcnt(0)
  buffer_store_dwordx4 v[44:47], v2, s[8:11], s45 offen offset:1024 sc1
  s_waitcnt vmcnt(8)
  v_readlane_b32 s43, v9, 2
  ds_read_b64_tr_b16 v[48:49], v13 offset:8192
  ds_read_b64_tr_b16 v[50:51], v13 offset:8704
  ds_read_b64_tr_b16 v[52:53], v14 offset:8192
  ds_read_b64_tr_b16 v[54:55], v14 offset:8704
  ds_read_b64_tr_b16 v[56:57], v13 offset:10240
  ds_read_b64_tr_b16 v[58:59], v13 offset:10752
  ds_read_b64_tr_b16 v[60:61], v14 offset:10240
  ds_read_b64_tr_b16 v[62:63], v14 offset:10752
  s_add_u32 s45, s43, s44
  s_waitcnt lgkmcnt(6)
  buffer_store_dwordx4 v[48:51], v2, s[8:11], s43 offen offset:0 sc1
  s_waitcnt lgkmcnt(4)
  buffer_store_dwordx4 v[52:55], v2, s[8:11], s45 offen offset:0 sc1
  s_waitcnt lgkmcnt(2)
  buffer_store_dwordx4 v[56:59], v2, s[8:11], s43 offen offset:1024 sc1
  s_waitcnt lgkmcnt(0)
  buffer_store_dwordx4 v[60:63], v2, s[8:11], s45 offen offset:1024 sc1
  s_mov_b32 s62, 0
L_adaL_atL_pa1:
  ds_read_b32 v4, v3 offset:16
  s_add_u32 s62, s62, 1
  s_waitcnt lgkmcnt(0)
  s_cmp_gt_u32 s62, 0x1000000
  v_readfirstlane_b32 s63, v4
  s_cbranch_scc1 L_adaL_atL_pa1x
  s_cmp_ge_u32 s63, s47
  s_cbranch_scc1 L_adaL_atL_pa1x
  s_sleep 8
  s_branch L_adaL_atL_pa1
L_adaL_atL_pa1x:
  s_add_u32 s47, s47, 3
  s_sub_u32 s42, s42, 12288
  s_mov_b32 m0, s42
  s_add_u32 s42, s42, 1024
  buffer_load_dwordx4 v12, s[12:15], s40 offen lds
  s_add_u32 s40, s40, s41
  s_mov_b32 m0, s42
  s_add_u32 s42, s42, 1024
  buffer_load_dwordx4 v12, s[12:15], s40 offen lds
  s_add_u32 s40, s40, s41
  s_mov_b32 m0, s42
  s_add_u32 s42, s42, 1024
  buffer_load_dwordx4 v12, s[12:15], s40 offen lds
  s_add_u32 s40, s40, s41
  s_mov_b32 m0, s42
  s_add_u32 s42, s42, 1024
  buffer_load_dwordx4 v12, s[12:15], s40 offen lds
  s_add_u32 s40, s40, s41
  s_mov_b32 m0, s42
  s_add_u32 s42, s42, 1024
  buffer_load_dwordx4 v12, s[12:15], s40 offen lds
  s_add_u32 s40, s40, s41
  s_mov_b32 m0, s42
  s_add_u32 s42, s42, 1024
  buffer_load_dwordx4 v12, s[12:15], s40 offen lds
  s_add_u32 s40, s40, s41
  s_mov_b32 m0, s42
  s_add_u32 s42, s42, 1024
  buffer_load_dwordx4 v12, s[12:15], s40 offen lds
  s_add_u32 s40, s40, s41
  s_mov_b32 m0, s42
  s_add_u32 s42, s42, 1024
  buffer_load_dwordx4 v12, s[12:15], s40 offen lds
  s_add_u32 s40, s40, s41
  s_mov_b32 m0, s42
  s_add_u32 s42, s42, 1024
  buffer_load_dwordx4 v12, s[12:15], s40 offen lds
  s_add_u32 s40, s40, s41
  s_mov_b32 m0, s42
  s_add_u32 s42, s42, 1024
  buffer_load_dwordx4 v12, s[12:15], s40 offen lds
  s_add_u32 s40, s40, s41
  s_mov_b32 m0, s42
  s_add_u32 s42, s42, 1024
  buffer_load_dwordx4 v12, s[12:15], s40 offen lds
  s_add_u32 s40, s40, s41
  s_mov_b32 m0, s42
  s_add_u32 s42, s42, 1024
  buffer_load_dwordx4 v12, s[12:15], s40 offen lds
  s_add_u32 s40, s40, s41
  s_waitcnt vmcnt(8)
  v_readlane_b32 s43, v9, 3
  ds_read_b64_tr_b16 v[16:17], v13 offset:0
  ds_read_b64_tr_b16 v[18:19], v13 offset:512
  ds_read_b64_tr_b16 v[20:21], v14 offset:0
  ds_read_b64_tr_b16 v[22:23], v14 offset:512
  ds_read_b64_tr_b16 v[24:25], v13 offset:2048
  ds_read_b64_tr_b16 v[26:27], v13 offset:2560
  ds_read_b64_tr_b16 v[28:29], v14 offset:2048
  ds_read_b64_tr_b16 v[30:31], v14 offset:2560
  s_add_u32 s45, s43, s44
  s_waitcnt lgkmcnt(6)
  buffer_store_dwordx4 v[16:19], v2, s[8:11], s43 offen offset:0 sc1
  s_waitcnt lgkmcnt(4)
  buffer_store_dwordx4 v[20:23], v2, s[8:11], s45 offen offset:0 sc1
  s_waitcnt lgkmcnt(2)
  buffer_store_dwordx4 v[24:27], v2, s[8:11], s43 offen offset:1024 sc1
  s_waitcnt lgkmcnt(0)
  buffer_store_dwordx4 v[28:31], v2, s[8:11], s45 offen offset:1024 sc1
  s_waitcnt vmcnt(8)
  v_readlane_b32 s43, v9, 4
  ds_read_b64_tr_b16 v[32:33], v13 offset:4096
  ds_read_b64_tr_b16 v[34:35], v13 offset:4608
  ds_read_b64_tr_b16 v[36:37], v14 offset:4096
  ds_read_b64_tr_b16 v[38:39], v14 offset:4608
  ds_read_b64_tr_b16 v[40:41], v13 offset:6144
  ds_read_b64_tr_b16 v[42:43], v13 offset:6656
  ds_read_b64_tr_b16 v[44:45], v14 offset:6144
  ds_read_b64_tr_b16 v[46:47], v14 offset:6656
  s_add_u32 s45, s43, s44
  s_waitcnt lgkmcnt(6)
  buffer_store_dwordx4 v[32:35], v2, s[8:11], s43 offen offset:0 sc1
  s_waitcnt lgkmcnt(4)
  buffer_store_dwordx4 v[36:39], v2, s[8:11], s45 offen offset:0 sc1
  s_waitcnt lgkmcnt(2)
  buffer_store_dwordx4 v[40:43], v2, s[8:11], s43 offen offset:1024 sc1
  s_waitcnt lgkmcnt(0)
  buffer_store_dwordx4 v[44:47], v2, s[8:11], s45 offen offset:1024 sc1
  s_waitcnt vmcnt(8)
  v_readlane_b32 s43, v9, 5
  ds_read_b64_tr_b16 v[48:49], v13 offset:8192
  ds_read_b64_tr_b16 v[50:51], v13 offset:8704
  ds_read_b64_tr_b16 v[52:53], v14 offset:8192
  ds_read_b64_tr_b16 v[54:55], v14 offset:8704
  ds_read_b64_tr_b16 v[56:57], v13 offset:10240
  ds_read_b64_tr_b16 v[58:59], v13 offset:10752
  ds_read_b64_tr_b16 v[60:61], v14 offset:10240
  ds_read_b64_tr_b16 v[62:63], v14 offset:10752
  s_add_u32 s45, s43, s44
  s_waitcnt lgkmcnt(6)
  buffer_store_dwordx4 v[48:51], v2, s[8:11], s43 offen offset:0 sc1
  s_waitcnt lgkmcnt(4)
  buffer_store_dwordx4 v[52:55], v2, s[8:11], s45 offen offset:0 sc1
  s_waitcnt lgkmcnt(2)
  buffer_store_dwordx4 v[56:59], v2, s[8:11], s43 offen offset:1024 sc1
  s_waitcnt lgkmcnt(0)
  buffer_store_dwordx4 v[60:63], v2, s[8:11], s45 offen offset:1024 sc1
  s_mov_b32 s62, 0
L_adaL_atL_pa2:
  ds_read_b32 v4, v3 offset:16
  s_add_u32 s62, s62, 1
  s_waitcnt lgkmcnt(0)
  s_cmp_gt_u32 s62, 0x1000000
  v_readfirstlane_b32 s63, v4
  s_cbranch_scc1 L_adaL_atL_pa2x
  s_cmp_ge_u32 s63, s47
  s_cbranch_scc1 L_adaL_atL_pa2x
  s_sleep 8
  s_branch L_adaL_atL_pa2
L_adaL_atL_pa2x:
  s_add_u32 s47, s47, 3
  s_sub_u32 s42, s42, 12288
  s_mov_b32 m0, s42
  s_add_u32 s42, s42, 1024
  buffer_load_dwordx4 v12, s[12:15], s40 offen lds
  s_add_u32 s40, s40, s41
  s_mov_b32 m0, s42
  s_add_u32 s42, s42, 1024
  buffer_load_dwordx4 v12, s[12:15], s40 offen lds
  s_add_u32 s40, s40, s41
  s_mov_b32 m0, s42
  s_add_u32 s42, s42, 1024
  buffer_load_dwordx4 v12, s[12:15], s40 offen lds
  s_add_u32 s40, s40, s41
  s_mov_b32 m0, s42
  s_add_u32 s42, s42, 1024
  buffer_load_dwordx4 v12, s[12:15], s40 offen lds
  s_add_u32 s40, s40, s41
  s_mov_b32 m0, s42
  s_add_u32 s42, s42, 1024
  buffer_load_dwordx4 v12, s[12:15], s40 offen lds
  s_add_u32 s40, s40, s41
  s_mov_b32 m0, s42
  s_add_u32 s42, s42, 1024
  buffer_load_dwordx4 v12, s[12:15], s40 offen lds
  s_add_u32 s40, s40, s41
  s_mov_b32 m0, s42
  s_add_u32 s42, s42, 1024
  buffer_load_dwordx4 v12, s[12:15], s40 offen lds
  s_add_u32 s40, s40, s41
  s_mov_b32 m0, s42
  s_add_u32 s42, s42, 1024
  buffer_load_dwordx4 v12, s[12:15], s40 offen lds
  s_add_u32 s40, s40, s41
  s_waitcnt vmcnt(4)
  v_readlane_b32 s43, v9, 6
  ds_read_b64_tr_b16 v[16:17], v13 offset:0
  ds_read_b64_tr_b16 v[18:19], v13 offset:512
  ds_read_b64_tr_b16 v[20:21], v14 offset:0
  ds_read_b64_tr_b16 v[22:23], v14 offset:512
  ds_read_b64_tr_b16 v[24:25], v13 offset:2048
  ds_read_b64_tr_b16 v[26:27], v13 offset:2560
  ds_read_b64_tr_b16 v[28:29], v14 offset:2048
  ds_read_b64_tr_b16 v[30:31], v14 offset:2560
  s_add_u32 s45, s43, s44
  s_waitcnt lgkmcnt(6)
  buffer_store_dwordx4 v[16:19], v2, s[8:11], s43 offen offset:0 sc1
  s_waitcnt lgkmcnt(4)
  buffer_store_dwordx4 v[20:23], v2, s[8:11], s45 offen offset:0 sc1
  s_waitcnt lgkmcnt(2)
  buffer_store_dwordx4 v[24:27], v2, s[8:11], s43 offen offset:1024 sc1
  s_waitcnt lgkmcnt(0)
  buffer_store_dwordx4 v[28:31], v2, s[8:11], s45 offen offset:1024 sc1
  s_waitcnt vmcnt(4)
  v_readlane_b32 s43, v9, 7
  ds_read_b64_tr_b16 v[32:33], v13 offset:4096
  ds_read_b64_tr_b16 v[34:35], v13 offset:4608
  ds_read_b64_tr_b16 v[36:37], v14 offset:4096
  ds_read_b64_tr_b16 v[38:39], v14 offset:4608
  ds_read_b64_tr_b16 v[40:41], v13 offset:6144
  ds_read_b64_tr_b16 v[42:43], v13 offset:6656
  ds_read_b64_tr_b16 v[44:45], v14 offset:6144
  ds_read_b64_tr_b16 v[46:47], v14 offset:6656
  s_add_u32 s45, s43, s44
  s_waitcnt lgkmcnt(6)
  buffer_store_dwordx4 v[32:35], v2, s[8:11], s43 offen offset:0 sc1
  s_waitcnt lgkmcnt(4)
  buffer_store_dwordx4 v[36:39], v2, s[8:11], s45 offen offset:0 sc1
  s_waitcnt lgkmcnt(2)
  buffer_store_dwordx4 v[40:43], v2, s[8:11], s43 offen offset:1024 sc1
  s_waitcnt lgkmcnt(0)
  buffer_store_dwordx4 v[44:47], v2, s[8:11], s45 offen offset:1024 sc1
  s_lshl_b32 s40, s3, 2
  v_add_u32 v58, s40, v3
  v_mov_b32 v59, 1
  ds_write_b32 v58, v59 offset:16
  s_cmp_lt_u32 s2, 224
  s_cbranch_scc1 L_adaL_atL_svfin
  s_and_b32 s40, s2, 15
  s_lshl_b32 s40, s40, 7
  s_add_u32 s40, s40, 395328
  v_mov_b32 v58, 0
  v_mov_b32 v59, 1
  s_mov_b64 exec, 1
  s_waitcnt vmcnt(0)
  buffer_atomic_add v59, v58, s[8:11], s40 offen sc1
  s_mov_b64 exec, -1
  s_branch L_adaL_atL_svfin
L_adaL_atL_modw:
  s_mov_b32 s12, s78
  s_and_b32 s13, s79, 0xffff
  s_mov_b32 s14, 12582912
  s_mov_b32 s15, 0x20000
  s_lshl_b32 s50, s16, 5
  s_add_u32 s50, s50, s17
  s_lshl_b32 s40, s50, 5
  s_add_u32 s40, s40, 4096
  s_mov_b32 s41, 393216
  s_mov_b32 s42, 155648
  v_lshrrev_b32 v12, 1, v0
  v_mul_u32_u24 v12, 12288, v12
  v_and_b32 v14, 1, v0
  v_lshl_add_u32 v12, v14, 4, v12
  v_lshrrev_b32 v14, 4, v0
  v_and_b32 v15, 15, v0
  v_lshlrev_b32 v13, 8, v14
  v_lshl_add_u32 v13, v15, 3, v13
  v_add_u32 v13, 155648, v13
  v_lshlrev_b32 v14, 4, v14
  s_mov_b32 s30, 57344
  s_mul_i32 s31, s17, 393216
  s_lshl_b32 s32, s16, 10
  s_add_u32 s31, s31, s32
  s_add_u32 s31, s31, 4096
  v_lshrrev_b32 v10, 3, v0
  v_mul_u32_u24 v10, 12288, v10
  v_and_b32 v11, 7, v0
  v_lshl_add_u32 v10, v11, 7, v10
  s_barrier
  s_mov_b32 s62, 0
L_adaL_atL_pm:
  ds_read_b32 v4, v3 offset:0
  s_add_u32 s62, s62, 1
  s_waitcnt lgkmcnt(0)
  s_cmp_gt_u32 s62, 0x1000000
  v_readfirstlane_b32 s63, v4
  s_cbranch_scc1 L_adaL_atL_pmx
  s_cmp_ge_u32 s63, 1
  s_cbranch_scc1 L_adaL_atL_pmx
  s_sleep 8
  s_branch L_adaL_atL_pm
L_adaL_atL_pmx:
  buffer_load_dwordx4 v[64:67], v14, s[8:11], s30 offen offset:0 sc1
  buffer_load_dwordx4 v[68:71], v14, s[8:11], s30 offen offset:64 sc1
  buffer_load_dwordx4 v[72:75], v14, s[8:11], s30 offen offset:128 sc1
  buffer_load_dwordx4 v[76:79], v14, s[8:11], s30 offen offset:192 sc1
  buffer_load_dwordx4 v[80:83], v14, s[8:11], s30 offen offset:256 sc1
  buffer_load_dwordx4 v[84:87], v14, s[8:11], s30 offen offset:320 sc1
  buffer_load_dwordx4 v[88:91], v14, s[8:11], s30 offen offset:384 sc1
  buffer_load_dwordx4 v[92:95], v14, s[8:11], s30 offen offset:448 sc1
  buffer_load_dwordx4 v[96:99], v14, s[8:11], s30 offen offset:512 sc1
  buffer_load_dwordx4 v[100:103], v14, s[8:11], s30 offen offset:576 sc1
  buffer_load_dwordx4 v[104:107], v14, s[8:11], s30 offen offset:640 sc1
  buffer_load_dwordx4 v[108:111], v14, s[8:11], s30 offen offset:704 sc1
  buffer_load_dwordx4 v[112:115], v14, s[8:11], s30 offen offset:768 sc1
  buffer_load_dwordx4 v[116:119], v14, s[8:11], s30 offen offset:832 sc1
  buffer_load_dwordx4 v[120:123], v14, s[8:11], s30 offen offset:896 sc1
  buffer_load_dwordx4 v[124:127], v14, s[8:11], s30 offen offset:960 sc1
  buffer_load_dwordx4 v[128:131], v14, s[8:11], s30 offen offset:1024 sc1
  buffer_load_dwordx4 v[132:135], v14, s[8:11], s30 offen offset:1088 sc1
  buffer_load_dwordx4 v[136:139], v14, s[8:11], s30 offen offset:1152 sc1
  buffer_load_dwordx4 v[140:143], v14, s[8:11], s30 offen offset:1216 sc1
  buffer_load_dwordx4 v[144:147], v14, s[8:11], s30 offen offset:1280 sc1
  buffer_load_dwordx4 v[148:151], v14, s[8:11], s30 offen offset:1344 sc1
  buffer_load_dwordx4 v[152:155], v14, s[8:11], s30 offen offset:1408 sc1
  buffer_load_dwordx4 v[156:159], v14, s[8:11], s30 offen offset:1472 sc1
  buffer_load_dwordx4 v[160:163], v14, s[8:11], s30 offen offset:1536 sc1
  buffer_load_dwordx4 v[164:167], v14, s[8:11], s30 offen offset:1600 sc1
  buffer_load_dwordx4 v[168:171], v14, s[8:11], s30 offen offset:1664 sc1
  buffer_load_dwordx4 v[172:175], v14, s[8:11], s30 offen offset:1728 sc1
  buffer_load_dwordx4 v[176:179], v14, s[8:11], s30 offen offset:1792 sc1
  buffer_load_dwordx4 v[180:183], v14, s[8:11], s30 offen offset:1856 sc1
  buffer_load_dwordx4 v[184:187], v14, s[8:11], s30 offen offset:1920 sc1
  buffer_load_dwordx4 v[188:191], v14, s[8:11], s30 offen offset:1984 sc1
  v_mov_b32 v48, 0
  v_mov_b32 v49, 0
  v_mov_b32 v50, 0
  v_mov_b32 v51, 0
  s_mul_i32 s47, s17, 43
  s_lshr_b32 s47, s47, 7
  s_mul_i32 s47, s47, 3
  s_sub_u32 s47, s17, s47
  s_min_u32 s47, s47, 1
  s_add_u32 s47, s47, 4
  s_mov_b32 s62, 0
L_adaL_atL_pt:
  ds_read_b32 v4, v3 offset:16
  s_add_u32 s62, s62, 1
  s_waitcnt lgkmcnt(0)
  s_cmp_gt_u32 s62, 0x1000000
  v_readfirstlane_b32 s63, v4
  s_cbranch_scc1 L_adaL_atL_ptx
  s_cmp_ge_u32 s63, s47
  s_cbranch_scc1 L_adaL_atL_ptx
  s_sleep 8
  s_branch L_adaL_atL_pt
L_adaL_atL_ptx:
  buffer_load_dword v11, v10, s[12:15], s31 offen
  s_add_u32 s31, s31, 98304
  buffer_load_dword v11, v10, s[12:15], s31 offen
  s_add_u32 s31, s31, 98304
  buffer_load_dword v11, v10, s[12:15], s31 offen
  s_add_u32 s31, s31, 98304
  buffer_load_dword v11, v10, s[12:15], s31 offen
  s_add_u32 s31, s31, 98304
  s_mov_b32 s62, 0
L_adaL_atL_pd0:
  ds_read_b32 v4, v3 offset:16
  s_add_u32 s62, s62, 1
  s_waitcnt lgkmcnt(0)
  s_cmp_gt_u32 s62, 0x1000000
  v_readfirstlane_b32 s63, v4
  s_cbranch_scc1 L_adaL_atL_pd0x
  s_cmp_ge_u32 s63, 9
  s_cbranch_scc1 L_adaL_atL_pd0x
  s_sleep 8
  s_branch L_adaL_atL_pd0
L_adaL_atL_pd0x:
  s_mov_b32 s42, 155648
  s_mov_b32 m0, s42
  s_add_u32 s42, s42, 1024
  buffer_load_dwordx4 v12, s[12:15], s40 offen lds
  s_add_u32 s40, s40, s41
  s_mov_b32 m0, s42
  s_add_u32 s42, s42, 1024
  buffer_load_dwordx4 v12, s[12:15], s40 offen lds
  s_add_u32 s40, s40, s41
  s_mov_b32 m0, s42
  s_add_u32 s42, s42, 1024
  buffer_load_dwordx4 v12, s[12:15], s40 offen lds
  s_add_u32 s40, s40, s41
  s_mov_b32 m0, s42
  s_add_u32 s42, s42, 1024
  buffer_load_dwordx4 v12, s[12:15], s40 offen lds
  s_add_u32 s40, s40, s41
  s_waitcnt vmcnt(0)
  ds_read_b64_tr_b16 v[16:17], v13 offset:0
  ds_read_b64_tr_b16 v[18:19], v13 offset:128
  ds_read_b64_tr_b16 v[20:21], v13 offset:1024
  ds_read_b64_tr_b16 v[22:23], v13 offset:1152
  ds_read_b64_tr_b16 v[24:25], v13 offset:2048
  ds_read_b64_tr_b16 v[26:27], v13 offset:2176
  ds_read_b64_tr_b16 v[28:29], v13 offset:3072
  ds_read_b64_tr_b16 v[30:31], v13 offset:3200
  s_waitcnt lgkmcnt(0)
  v_mfma_f32_16x16x32_bf16 v[48:51], v[64:67], v[16:19], v[48:51]
  v_mfma_f32_16x16x32_bf16 v[48:51], v[68:71], v[20:23], v[48:51]
  v_mfma_f32_16x16x32_bf16 v[48:51], v[72:75], v[24:27], v[48:51]
  v_mfma_f32_16x16x32_bf16 v[48:51], v[76:79], v[28:31], v[48:51]
  s_mov_b32 s62, 0
L_adaL_atL_pd1:
  ds_read_b32 v4, v3 offset:16
  s_add_u32 s62, s62, 1
  s_waitcnt lgkmcnt(0)
  s_cmp_gt_u32 s62, 0x1000000
  v_readfirstlane_b32 s63, v4
  s_cbranch_scc1 L_adaL_atL_pd1x
  s_cmp_ge_u32 s63, 10
  s_cbranch_scc1 L_adaL_atL_pd1x
  s_sleep 8
  s_branch L_adaL_atL_pd1
L_adaL_atL_pd1x:
  s_mov_b32 s42, 155648
  s_mov_b32 m0, s42
  s_add_u32 s42, s42, 1024
  buffer_load_dwordx4 v12, s[12:15], s40 offen lds
  s_add_u32 s40, s40, s41
  s_mov_b32 m0, s42
  s_add_u32 s42, s42, 1024
  buffer_load_dwordx4 v12, s[12:15], s40 offen lds
  s_add_u32 s40, s40, s41
  s_mov_b32 m0, s42
  s_add_u32 s42, s42, 1024
  buffer_load_dwordx4 v12, s[12:15], s40 offen lds
  s_add_u32 s40, s40, s41
  s_mov_b32 m0, s42
  s_add_u32 s42, s42, 1024
  buffer_load_dwordx4 v12, s[12:15], s40 offen lds
  s_add_u32 s40, s40, s41
  s_waitcnt vmcnt(0)
  ds_read_b64_tr_b16 v[32:33], v13 offset:0
  ds_read_b64_tr_b16 v[34:35], v13 offset:128
  ds_read_b64_tr_b16 v[36:37], v13 offset:1024
  ds_read_b64_tr_b16 v[38:39], v13 offset:1152
  ds_read_b64_tr_b16 v[40:41], v13 offset:2048
  ds_read_b64_tr_b16 v[42:43], v13 offset:2176
  ds_read_b64_tr_b16 v[44:45], v13 offset:3072
  ds_read_b64_tr_b16 v[46:47], v13 offset:3200
  s_waitcnt lgkmcnt(0)
  v_mfma_f32_16x16x32_bf16 v[48:51], v[80:83], v[32:35], v[48:51]
  v_mfma_f32_16x16x32_bf16 v[48:51], v[84:87], v[36:39], v[48:51]
  v_mfma_f32_16x16x32_bf16 v[48:51], v[88:91], v[40:43], v[48:51]
  v_mfma_f32_16x16x32_bf16 v[48:51], v[92:95], v[44:47], v[48:51]
  s_mov_b32 s62, 0
L_adaL_atL_pd2:
  ds_read_b32 v4, v3 offset:16
  s_add_u32 s62, s62, 1
  s_waitcnt lgkmcnt(0)
  s_cmp_gt_u32 s62, 0x1000000
  v_readfirstlane_b32 s63, v4
  s_cbranch_scc1 L_adaL_atL_pd2x
  s_cmp_ge_u32 s63, 11
  s_cbranch_scc1 L_adaL_atL_pd2x
  s_sleep 8
  s_branch L_adaL_atL_pd2
L_adaL_atL_pd2x:
  s_mov_b32 s42, 155648
  s_mov_b32 m0, s42
  s_add_u32 s42, s42, 1024
  buffer_load_dwordx4 v12, s[12:15], s40 offen lds
  s_add_u32 s40, s40, s41
  s_mov_b32 m0, s42
  s_add_u32 s42, s42, 1024
  buffer_load_dwordx4 v12, s[12:15], s40 offen lds
  s_add_u32 s40, s40, s41
  s_mov_b32 m0, s42
  s_add_u32 s42, s42, 1024
  buffer_load_dwordx4 v12, s[12:15], s40 offen lds
  s_add_u32 s40, s40, s41
  s_mov_b32 m0, s42
  s_add_u32 s42, s42, 1024
  buffer_load_dwordx4 v12, s[12:15], s40 offen lds
  s_add_u32 s40, s40, s41
  s_waitcnt vmcnt(0)
  ds_read_b64_tr_b16 v[16:17], v13 offset:0
  ds_read_b64_tr_b16 v[18:19], v13 offset:128
  ds_read_b64_tr_b16 v[20:21], v13 offset:1024
  ds_read_b64_tr_b16 v[22:23], v13 offset:1152
  ds_read_b64_tr_b16 v[24:25], v13 offset:2048
  ds_read_b64_tr_b16 v[26:27], v13 offset:2176
  ds_read_b64_tr_b16 v[28:29], v13 offset:3072
  ds_read_b64_tr_b16 v[30:31], v13 offset:3200
  s_waitcnt lgkmcnt(0)
  v_mfma_f32_16x16x32_bf16 v[48:51], v[96:99], v[16:19], v[48:51]
  v_mfma_f32_16x16x32_bf16 v[48:51], v[100:103], v[20:23], v[48:51]
  v_mfma_f32_16x16x32_bf16 v[48:51], v[104:107], v[24:27], v[48:51]
  v_mfma_f32_16x16x32_bf16 v[48:51], v[108:111], v[28:31], v[48:51]
  s_mov_b32 s62, 0
L_adaL_atL_pd3:
  ds_read_b32 v4, v3 offset:16
  s_add_u32 s62, s62, 1
  s_waitcnt lgkmcnt(0)
  s_cmp_gt_u32 s62, 0x1000000
  v_readfirstlane_b32 s63, v4
  s_cbranch_scc1 L_adaL_atL_pd3x
  s_cmp_ge_u32 s63, 12
  s_cbranch_scc1 L_adaL_atL_pd3x
  s_sleep 8
  s_branch L_adaL_atL_pd3
L_adaL_atL_pd3x:
  s_mov_b32 s42, 155648
  s_mov_b32 m0, s42
  s_add_u32 s42, s42, 1024
  buffer_load_dwordx4 v12, s[12:15], s40 offen lds
  s_add_u32 s40, s40, s41
  s_mov_b32 m0, s42
  s_add_u32 s42, s42, 1024
  buffer_load_dwordx4 v12, s[12:15], s40 offen lds
  s_add_u32 s40, s40, s41
  s_mov_b32 m0, s42
  s_add_u32 s42, s42, 1024
  buffer_load_dwordx4 v12, s[12:15], s40 offen lds
  s_add_u32 s40, s40, s41
  s_mov_b32 m0, s42
  s_add_u32 s42, s42, 1024
  buffer_load_dwordx4 v12, s[12:15], s40 offen lds
  s_add_u32 s40, s40, s41
  s_waitcnt vmcnt(0)
  ds_read_b64_tr_b16 v[32:33], v13 offset:0
  ds_read_b64_tr_b16 v[34:35], v13 offset:128
  ds_read_b64_tr_b16 v[36:37], v13 offset:1024
  ds_read_b64_tr_b16 v[38:39], v13 offset:1152
  ds_read_b64_tr_b16 v[40:41], v13 offset:2048
  ds_read_b64_tr_b16 v[42:43], v13 offset:2176
  ds_read_b64_tr_b16 v[44:45], v13 offset:3072
  ds_read_b64_tr_b16 v[46:47], v13 offset:3200
  s_waitcnt lgkmcnt(0)
  v_mfma_f32_16x16x32_bf16 v[48:51], v[112:115], v[32:35], v[48:51]
  v_mfma_f32_16x16x32_bf16 v[48:51], v[116:119], v[36:39], v[48:51]
  v_mfma_f32_16x16x32_bf16 v[48:51], v[120:123], v[40:43], v[48:51]
  v_mfma_f32_16x16x32_bf16 v[48:51], v[124:127], v[44:47], v[48:51]
  s_mov_b32 s62, 0
L_adaL_atL_pd4:
  ds_read_b32 v4, v3 offset:16
  s_add_u32 s62, s62, 1
  s_waitcnt lgkmcnt(0)
  s_cmp_gt_u32 s62, 0x1000000
  v_readfirstlane_b32 s63, v4
  s_cbranch_scc1 L_adaL_atL_pd4x
  s_cmp_ge_u32 s63, 13
  s_cbranch_scc1 L_adaL_atL_pd4x
  s_sleep 8
  s_branch L_adaL_atL_pd4
L_adaL_atL_pd4x:
  s_mov_b32 s42, 155648
  s_mov_b32 m0, s42
  s_add_u32 s42, s42, 1024
  buffer_load_dwordx4 v12, s[12:15], s40 offen lds
  s_add_u32 s40, s40, s41
  s_mov_b32 m0, s42
  s_add_u32 s42, s42, 1024
  buffer_load_dwordx4 v12, s[12:15], s40 offen lds
  s_add_u32 s40, s40, s41
  s_mov_b32 m0, s42
  s_add_u32 s42, s42, 1024
  buffer_load_dwordx4 v12, s[12:15], s40 offen lds
  s_add_u32 s40, s40, s41
  s_mov_b32 m0, s42
  s_add_u32 s42, s42, 1024
  buffer_load_dwordx4 v12, s[12:15], s40 offen lds
  s_add_u32 s40, s40, s41
  s_waitcnt vmcnt(0)
  ds_read_b64_tr_b16 v[16:17], v13 offset:0
  ds_read_b64_tr_b16 v[18:19], v13 offset:128
  ds_read_b64_tr_b16 v[20:21], v13 offset:1024
  ds_read_b64_tr_b16 v[22:23], v13 offset:1152
  ds_read_b64_tr_b16 v[24:25], v13 offset:2048
  ds_read_b64_tr_b16 v[26:27], v13 offset:2176
  ds_read_b64_tr_b16 v[28:29], v13 offset:3072
  ds_read_b64_tr_b16 v[30:31], v13 offset:3200
  s_waitcnt lgkmcnt(0)
  v_mfma_f32_16x16x32_bf16 v[48:51], v[128:131], v[16:19], v[48:51]
  v_mfma_f32_16x16x32_bf16 v[48:51], v[132:135], v[20:23], v[48:51]
  v_mfma_f32_16x16x32_bf16 v[48:51], v[136:139], v[24:27], v[48:51]
  v_mfma_f32_16x16x32_bf16 v[48:51], v[140:143], v[28:31], v[48:51]
  s_mov_b32 s62, 0
L_adaL_atL_pd5:
  ds_read_b32 v4, v3 offset:16
  s_add_u32 s62, s62, 1
  s_waitcnt lgkmcnt(0)
  s_cmp_gt_u32 s62, 0x1000000
  v_readfirstlane_b32 s63, v4
  s_cbranch_scc1 L_adaL_atL_pd5x
  s_cmp_ge_u32 s63, 14
  s_cbranch_scc1 L_adaL_atL_pd5x
  s_sleep 8
  s_branch L_adaL_atL_pd5
L_adaL_atL_pd5x:
  s_mov_b32 s42, 155648
  s_mov_b32 m0, s42
  s_add_u32 s42, s42, 1024
  buffer_load_dwordx4 v12, s[12:15], s40 offen lds
  s_add_u32 s40, s40, s41
  s_mov_b32 m0, s42
  s_add_u32 s42, s42, 1024
  buffer_load_dwordx4 v12, s[12:15], s40 offen lds
  s_add_u32 s40, s40, s41
  s_mov_b32 m0, s42
  s_add_u32 s42, s42, 1024
  buffer_load_dwordx4 v12, s[12:15], s40 offen lds
  s_add_u32 s40, s40, s41
  s_mov_b32 m0, s42
  s_add_u32 s42, s42, 1024
  buffer_load_dwordx4 v12, s[12:15], s40 offen lds
  s_add_u32 s40, s40, s41
  s_waitcnt vmcnt(0)
  ds_read_b64_tr_b16 v[32:33], v13 offset:0
  ds_read_b64_tr_b16 v[34:35], v13 offset:128
  ds_read_b64_tr_b16 v[36:37], v13 offset:1024
  ds_read_b64_tr_b16 v[38:39], v13 offset:1152
  ds_read_b64_tr_b16 v[40:41], v13 offset:2048
  ds_read_b64_tr_b16 v[42:43], v13 offset:2176
  ds_read_b64_tr_b16 v[44:45], v13 offset:3072
  ds_read_b64_tr_b16 v[46:47], v13 offset:3200
  s_waitcnt lgkmcnt(0)
  v_mfma_f32_16x16x32_bf16 v[48:51], v[144:147], v[32:35], v[48:51]
  v_mfma_f32_16x16x32_bf16 v[48:51], v[148:151], v[36:39], v[48:51]
  v_mfma_f32_16x16x32_bf16 v[48:51], v[152:155], v[40:43], v[48:51]
  v_mfma_f32_16x16x32_bf16 v[48:51], v[156:159], v[44:47], v[48:51]
  s_mov_b32 s62, 0
L_adaL_atL_pd6:
  ds_read_b32 v4, v3 offset:16
  s_add_u32 s62, s62, 1
  s_waitcnt lgkmcnt(0)
  s_cmp_gt_u32 s62, 0x1000000
  v_readfirstlane_b32 s63, v4
  s_cbranch_scc1 L_adaL_atL_pd6x
  s_cmp_ge_u32 s63, 15
  s_cbranch_scc1 L_adaL_atL_pd6x
  s_sleep 8
  s_branch L_adaL_atL_pd6
L_adaL_atL_pd6x:
  s_mov_b32 s42, 155648
  s_mov_b32 m0, s42
  s_add_u32 s42, s42, 1024
  buffer_load_dwordx4 v12, s[12:15], s40 offen lds
  s_add_u32 s40, s40, s41
  s_mov_b32 m0, s42
  s_add_u32 s42, s42, 1024
  buffer_load_dwordx4 v12, s[12:15], s40 offen lds
  s_add_u32 s40, s40, s41
  s_mov_b32 m0, s42
  s_add_u32 s42, s42, 1024
  buffer_load_dwordx4 v12, s[12:15], s40 offen lds
  s_add_u32 s40, s40, s41
  s_mov_b32 m0, s42
  s_add_u32 s42, s42, 1024
  buffer_load_dwordx4 v12, s[12:15], s40 offen lds
  s_add_u32 s40, s40, s41
  s_waitcnt vmcnt(0)
  ds_read_b64_tr_b16 v[16:17], v13 offset:0
  ds_read_b64_tr_b16 v[18:19], v13 offset:128
  ds_read_b64_tr_b16 v[20:21], v13 offset:1024
  ds_read_b64_tr_b16 v[22:23], v13 offset:1152
  ds_read_b64_tr_b16 v[24:25], v13 offset:2048
  ds_read_b64_tr_b16 v[26:27], v13 offset:2176
  ds_read_b64_tr_b16 v[28:29], v13 offset:3072
  ds_read_b64_tr_b16 v[30:31], v13 offset:3200
  s_waitcnt lgkmcnt(0)
  v_mfma_f32_16x16x32_bf16 v[48:51], v[160:163], v[16:19], v[48:51]
  v_mfma_f32_16x16x32_bf16 v[48:51], v[164:167], v[20:23], v[48:51]
  v_mfma_f32_16x16x32_bf16 v[48:51], v[168:171], v[24:27], v[48:51]
  v_mfma_f32_16x16x32_bf16 v[48:51], v[172:175], v[28:31], v[48:51]
  s_mov_b32 s62, 0
L_adaL_atL_pd7:
  ds_read_b32 v4, v3 offset:16
  s_add_u32 s62, s62, 1
  s_waitcnt lgkmcnt(0)
  s_cmp_gt_u32 s62, 0x1000000
  v_readfirstlane_b32 s63, v4
  s_cbranch_scc1 L_adaL_atL_pd7x
  s_cmp_ge_u32 s63, 16
  s_cbranch_scc1 L_adaL_atL_pd7x
  s_sleep 8
  s_branch L_adaL_atL_pd7
L_adaL_atL_pd7x:
  s_mov_b32 s42, 155648
  s_mov_b32 m0, s42
  s_add_u32 s42, s42, 1024
  buffer_load_dwordx4 v12, s[12:15], s40 offen lds
  s_add_u32 s40, s40, s41
  s_mov_b32 m0, s42
  s_add_u32 s42, s42, 1024
  buffer_load_dwordx4 v12, s[12:15], s40 offen lds
  s_add_u32 s40, s40, s41
  s_mov_b32 m0, s42
  s_add_u32 s42, s42, 1024
  buffer_load_dwordx4 v12, s[12:15], s40 offen lds
  s_add_u32 s40, s40, s41
  s_mov_b32 m0, s42
  s_add_u32 s42, s42, 1024
  buffer_load_dwordx4 v12, s[12:15], s40 offen lds
  s_add_u32 s40, s40, s41
  s_waitcnt vmcnt(0)
  ds_read_b64_tr_b16 v[32:33], v13 offset:0
  ds_read_b64_tr_b16 v[34:35], v13 offset:128
  ds_read_b64_tr_b16 v[36:37], v13 offset:1024
  ds_read_b64_tr_b16 v[38:39], v13 offset:1152
  ds_read_b64_tr_b16 v[40:41], v13 offset:2048
  ds_read_b64_tr_b16 v[42:43], v13 offset:2176
  ds_read_b64_tr_b16 v[44:45], v13 offset:3072
  ds_read_b64_tr_b16 v[46:47], v13 offset:3200
  s_waitcnt lgkmcnt(0)
  v_mfma_f32_16x16x32_bf16 v[48:51], v[176:179], v[32:35], v[48:51]
  v_mfma_f32_16x16x32_bf16 v[48:51], v[180:183], v[36:39], v[48:51]
  v_mfma_f32_16x16x32_bf16 v[48:51], v[184:187], v[40:43], v[48:51]
  v_mfma_f32_16x16x32_bf16 v[48:51], v[188:191], v[44:47], v[48:51]
  s_nop 7
  v_cvt_pk_bf16_f32 v52, v48, v48
  v_lshlrev_b32 v48, 16, v52
  s_lshr_b32 s30, s50, 6
  s_cmp_eq_u32 s30, 2
  s_cselect_b32 s31, 1.0, 0
  v_add_f32 v48, s31, v48
  v_cvt_pk_bf16_f32 v52, v48, v48
  v_lshlrev_b32 v48, 16, v52
  v_lshlrev_b32 v14, 2, v15
  v_lshlrev_b32 v15, 1, v15
  s_lshl_b32 s30, s50, 6
  s_add_u32 s30, s30, 8192
  s_lshl_b32 s31, s50, 5
  s_add_u32 s31, s31, 36864
  buffer_store_dword v48, v14, s[8:11], s30 offen sc1
  buffer_store_short v52, v15, s[8:11], s31 offen sc1
  s_getpc_b64 s[60:61]
L_adaL_atL_pc5963:
  s_add_u32 s60, s60, adaLN_cond__softmax_full_mha__dense_activation_relu__prompt_kernel-L_adaL_atL_pc5963
  s_addc_u32 s61, s61, -1
  s_lshr_b32 s62, s2, 3
  s_lshl_b32 s62, s62, 11
  v_and_b32 v54, 15, v0
  v_lshlrev_b32 v54, 7, v54
  v_add_u32 v54, s62, v54
  v_min_u32 v54, adaLN_cond__softmax_full_mha__dense_activation_relu__prompt_kernel_end-adaLN_cond__softmax_full_mha__dense_activation_relu__prompt_kernel-4, v54
  v_mov_b32 v55, s61
  v_add_co_u32 v54, vcc, s60, v54
  s_nop 1
  v_addc_co_u32 v55, vcc, 0, v55, vcc
  global_load_dword v56, v[54:55], off
L_adaL_atL_svfin:
  s_waitcnt vmcnt(0) lgkmcnt(0)
  s_cmp_lt_u32 s3, 2
  s_cbranch_scc1 L_adaL_atL_vb
  s_lshl_b32 s54, s19, 7
  s_add_u32 s54, s54, 395328
  v_lshlrev_b32 v56, 7, v0
  s_mov_b32 s62, 0
  s_mov_b64 exec, 1
L_adaL_atL_pw:
  v_mov_b32 v57, 0
  buffer_atomic_add v57, v56, s[8:11], s54 offen sc0 sc1
  s_add_u32 s62, s62, 1
  s_cmp_gt_u32 s62, 0x80000
  s_cbranch_scc1 L_adaL_atL_pwx
  s_waitcnt vmcnt(0)
  v_cmp_gt_u32 vcc, 4, v57
  s_nop 3
  s_cbranch_vccz L_adaL_atL_pwx
  s_sleep 2
  s_branch L_adaL_atL_pw
L_adaL_atL_pwx:
  s_mov_b64 exec, -1
  s_mov_b32 s29, 0
  s_mov_b32 s30, 65536
  s_bfe_u32 s46, s19, 0x20002
  s_mul_i32 s28, s46, 16384
  s_mov_b32 s31, 0
  s_and_b32 s20, s3, 1
  s_lshl_b32 s21, s19, 1
  s_add_u32 s21, s21, s20
  s_mul_i32 s21, s21, 66560
  s_add_u32 s21, s21, 38535168
  v_add_u32 v8, s21, v2
  s_mul_i32 s25, s20, 4096
  s_add_u32 s25, s25, 65536
  s_mov_b32 s27, s25
  s_mov_b32 s62, 0
L_adaL_atL_ew0:
  ds_read_b128 v[4:7], v3 offset:0
  s_add_u32 s62, s62, 1
  s_waitcnt lgkmcnt(0)
  v_min3_u32 v4, v4, v5, v6
  v_min_u32 v4, v4, v7
  s_cmp_gt_u32 s62, 0x1000000
  v_readfirstlane_b32 s63, v4
  s_cbranch_scc1 L_adaL_atL_ew0x
  s_cmp_ge_u32 s63, 13
  s_cbranch_scc1 L_adaL_atL_ew0x
  s_sleep 4
  s_branch L_adaL_atL_ew0
L_adaL_atL_ew0x:
  s_mov_b32 m0, s27
  s_add_u32 s31, s31, 1
  buffer_load_dwordx4 v8, s[8:11], s28 offen offset:0 sc1 lds
  buffer_load_dwordx4 v8, s[8:11], s28 offen offset:1024 sc1 lds
  buffer_load_dwordx4 v8, s[8:11], s28 offen offset:2048 sc1 lds
  buffer_load_dwordx4 v8, s[8:11], s28 offen offset:3072 sc1 lds
  s_add_u32 s28, s28, 4096
  s_cmp_eq_u32 s28, s30
  s_cselect_b32 s28, s29, s28
  s_add_u32 s27, s27, 8192
  s_mov_b32 m0, s27
  s_add_u32 s31, s31, 1
  buffer_load_dwordx4 v8, s[8:11], s28 offen offset:0 sc1 lds
  buffer_load_dwordx4 v8, s[8:11], s28 offen offset:1024 sc1 lds
  buffer_load_dwordx4 v8, s[8:11], s28 offen offset:2048 sc1 lds
  buffer_load_dwordx4 v8, s[8:11], s28 offen offset:3072 sc1 lds
  s_add_u32 s28, s28, 4096
  s_cmp_eq_u32 s28, s30
  s_cselect_b32 s28, s29, s28
  s_add_u32 s27, s27, 8192
  s_mov_b32 s62, 0
L_adaL_atL_ew2:
  ds_read_b128 v[4:7], v3 offset:0
  s_add_u32 s62, s62, 1
  s_waitcnt lgkmcnt(0)
  v_min3_u32 v4, v4, v5, v6
  v_min_u32 v4, v4, v7
  s_cmp_gt_u32 s62, 0x1000000
  v_readfirstlane_b32 s63, v4
  s_cbranch_scc1 L_adaL_atL_ew2x
  s_cmp_ge_u32 s63, 14
  s_cbranch_scc1 L_adaL_atL_ew2x
  s_sleep 4
  s_branch L_adaL_atL_ew2
L_adaL_atL_ew2x:
  s_mov_b32 m0, s27
  s_add_u32 s31, s31, 1
  buffer_load_dwordx4 v8, s[8:11], s28 offen offset:0 sc1 lds
  buffer_load_dwordx4 v8, s[8:11], s28 offen offset:1024 sc1 lds
  buffer_load_dwordx4 v8, s[8:11], s28 offen offset:2048 sc1 lds
  buffer_load_dwordx4 v8, s[8:11], s28 offen offset:3072 sc1 lds
  s_add_u32 s28, s28, 4096
  s_cmp_eq_u32 s28, s30
  s_cselect_b32 s28, s29, s28
  s_add_u32 s27, s27, 8192
  s_mov_b32 m0, s27
  s_add_u32 s31, s31, 1
  buffer_load_dwordx4 v8, s[8:11], s28 offen offset:0 sc1 lds
  buffer_load_dwordx4 v8, s[8:11], s28 offen offset:1024 sc1 lds
  buffer_load_dwordx4 v8, s[8:11], s28 offen offset:2048 sc1 lds
  buffer_load_dwordx4 v8, s[8:11], s28 offen offset:3072 sc1 lds
  s_add_u32 s28, s28, 4096
  s_cmp_eq_u32 s28, s30
  s_cselect_b32 s28, s29, s28
  s_add_u32 s27, s27, 8192
L_adaL_atL_vb:
  s_barrier
  s_cmp_lg_u32 s3, 1
  s_cbranch_scc1 L_adaL_atL_nosig
  v_lshlrev_b32 v58, 7, v0
  v_mov_b32 v59, 1
  s_mov_b32 s40, 393216
  s_mov_b64 exec, 0xffff
  buffer_atomic_add v59, v58, s[8:11], s40 offen sc1
  s_mov_b64 exec, -1
L_adaL_atL_nosig:
  ds_read_b128 v[4:7], v3 offset:32
  s_waitcnt lgkmcnt(0)
  v_or3_b32 v4, v4, v5, v6
  v_or_b32 v4, v4, v7
  s_nop 0
  v_readfirstlane_b32 s26, v4
  s_nop 0
  s_cmp_eq_u32 s26, 0
  s_cbranch_scc0 L_adaL_atL_fb
  s_cmp_ge_u32 s3, 2
  s_cbranch_scc1 L_adaL_woL_wloop
  s_branch L_adaL_atL_done
L_adaL_atL_fb:
  s_waitcnt vmcnt(0)
  s_barrier
  s_barrier
  s_barrier
  s_barrier
L_adaL_atL_done:
  s_and_b32 s16, s2, 7
  s_lshr_b32 s17, s2, 3
  s_and_b32 s18, s16, 1
  s_lshl_b32 s18, s18, 3
  s_and_b32 s19, s17, 7
  s_add_u32 s18, s18, s19
  s_lshr_b32 s19, s16, 1
  s_lshl_b32 s19, s19, 2
  s_lshr_b32 s17, s17, 3
  s_add_u32 s19, s19, s17
  s_mov_b32 s29, 0
  s_add_u32 s30, s29, 65536
  s_bfe_u32 s46, s19, 131074
  s_mul_i32 s28, s46, 16384
  s_max_u32 s28, s28, s29
  s_mov_b32 s31, 0
  s_and_b32 s20, s3, 1
  s_cmp_ge_u32 s3, 2
  s_cbranch_scc1 L_adaL_woL_W
  v_mov_b32 v26, 163776
  s_mov_b32 s48, 0
  s_mov_b32 s49, 0
  v_lshlrev_b32 v56, 7, v0
  v_mov_b32 v57, 0
  s_lshl_b32 s50, s18, 9
  s_add_u32 s50, s50, 401408
  s_lshl_b32 s22, s18, 1
  s_add_u32 s22, s22, s20
  s_mul_i32 s22, s22, 133120
  s_add_u32 s22, s22, 17956864
  v_add_u32 v8, s22, v2
  v_add_u32 v9, 66560, v8
  s_mul_i32 s25, s20, 8192
  s_add_u32 s26, s25, 65536
  s_mov_b32 s27, s25
  s_mov_b32 s62, 0
  s_cmp_lg_u32 s3, 0
  s_cbranch_scc1 L_adaL_woL_spin
L_adaL_woL_dec:
  v_mov_b32 v57, 0
  s_mov_b64 exec, 15
  buffer_atomic_add v57, v56, s[8:11], s50 offen sc0 sc1
  s_mov_b64 exec, -1
  s_add_u32 s62, s62, 1
  s_waitcnt vmcnt(0)
  v_cmp_le_u32 vcc, 16, v57
  s_cmp_gt_u32 s62, 0x80000
  s_nop 2
  s_cselect_b32 s40, 15, vcc_lo
  s_and_b32 s40, s40, 15
  s_lshl_b32 s42, s40, 4
  s_or_b32 s40, s40, s42
  s_lshr_b32 s42, s40, s46
  s_ff0_i32_b32 s43, s42
  s_cmp_lt_u32 s43, 2
  s_cbranch_scc1 L_adaL_woL_dec
  s_mul_i32 s48, s43, 4
  s_sub_u32 s49, s48, 1
  v_mov_b32 v57, 0
  v_mov_b32 v27, 1
  ds_write_b32 v26, v27
  s_branch L_adaL_woL_have
L_adaL_woL_spin:
  ds_read_b32 v27, v26
  s_add_u32 s62, s62, 1
  s_waitcnt lgkmcnt(0)
  v_readfirstlane_b32 s44, v27
  s_cmp_gt_u32 s62, 0x2000000
  s_cselect_b32 s44, 1, s44
  s_cmp_lg_u32 s44, 0
  s_cbranch_scc1 L_adaL_woL_have
  s_sleep 1
  s_branch L_adaL_woL_spin
L_adaL_woL_have:
L_adaL_woL_xloop:
  s_cmp_lt_u32 s31, 3
  s_cbranch_scc1 L_adaL_woL_xskip
  s_waitcnt vmcnt(16)
  s_cmp_eq_u32 s31, s48
  s_cbranch_scc1 L_adaL_woL_chkb
L_adaL_woL_chkbr:
  s_barrier
L_adaL_woL_xskip:
  s_add_u32 m0, s27, 0
  s_nop 0
  buffer_load_dwordx4 v8, s[8:11], s28 offen offset:0 sc1 lds
  buffer_load_dwordx4 v8, s[8:11], s28 offen offset:1024 sc1 lds
  buffer_load_dwordx4 v8, s[8:11], s28 offen offset:2048 sc1 lds
  buffer_load_dwordx4 v8, s[8:11], s28 offen offset:3072 sc1 lds
  s_add_u32 m0, s27, 4096
  s_nop 0
  buffer_load_dwordx4 v9, s[8:11], s28 offen offset:0 sc1 lds
  buffer_load_dwordx4 v9, s[8:11], s28 offen offset:1024 sc1 lds
  buffer_load_dwordx4 v9, s[8:11], s28 offen offset:2048 sc1 lds
  buffer_load_dwordx4 v9, s[8:11], s28 offen offset:3072 sc1 lds
  s_add_u32 s28, s28, 4096
  s_cmp_eq_u32 s28, s30
  s_cselect_b32 s28, s29, s28
  s_add_u32 s27, s27, 16384
  s_cmp_eq_u32 s27, s26
  s_cselect_b32 s27, s25, s27
  s_add_u32 s31, s31, 1
  s_cmp_eq_u32 s31, s49
  s_cbranch_scc1 L_adaL_woL_chka
L_adaL_woL_chkar:
  s_cmp_lt_u32 s31, 16
  s_cbranch_scc1 L_adaL_woL_xloop
  s_waitcnt vmcnt(16)
  s_barrier
  s_waitcnt vmcnt(8)
  s_barrier
  s_waitcnt vmcnt(0)
  s_barrier
  s_branch L_adaL_woL_done
L_adaL_woL_W:
  s_lshl_b32 s21, s19, 1
  s_add_u32 s21, s21, s20
  s_mul_i32 s21, s21, 66560
  s_add_u32 s21, s21, 38535168
  v_add_u32 v8, s21, v2
  s_mul_i32 s25, s20, 4096
  s_add_u32 s25, s25, 65536
  s_add_u32 s26, s25, 90112
  s_add_u32 s27, s25, 0
L_adaL_woL_wloop:
  s_add_u32 s26, s25, 90112
  s_cmp_lt_u32 s31, 10
  s_cbranch_scc1 L_adaL_woL_wskip
  s_waitcnt vmcnt(36)
  s_barrier
L_adaL_woL_wskip:
  s_add_u32 m0, s27, 0
  s_nop 0
  buffer_load_dwordx4 v8, s[8:11], s28 offen offset:0 sc1 lds
  buffer_load_dwordx4 v8, s[8:11], s28 offen offset:1024 sc1 lds
  buffer_load_dwordx4 v8, s[8:11], s28 offen offset:2048 sc1 lds
  buffer_load_dwordx4 v8, s[8:11], s28 offen offset:3072 sc1 lds
  s_add_u32 s28, s28, 4096
  s_cmp_eq_u32 s28, s30
  s_cselect_b32 s28, s29, s28
  s_add_u32 s27, s27, 8192
  s_cmp_eq_u32 s27, s26
  s_cselect_b32 s27, s25, s27
  s_add_u32 s31, s31, 1
  s_cmp_lt_u32 s31, 16
  s_cbranch_scc1 L_adaL_woL_wloop
  s_waitcnt vmcnt(36)
  s_barrier
  s_and_b32 s47, s2, 15
  s_lshl_b32 s47, s47, 7
  s_add_u32 s47, s47, 393216
  v_mov_b32 v22, 0
  v_mov_b32 v23, 0
  s_mov_b64 exec, 1
  buffer_atomic_add v23, v22, s[8:11], s47 offen sc0 sc1
  s_mov_b64 exec, -1
  v_lshrrev_b32 v20, 4, v0
  v_and_b32 v21, 15, v0
  v_lshlrev_b32 v24, 9, v20
  v_lshl_add_u32 v24, v21, 4, v24
  v_and_b32 v25, 1, v0
  v_xor_b32 v25, 1, v25
  v_lshlrev_b32 v25, 11, v25
  v_lshl_add_u32 v25, v20, 4, v25
  s_lshr_b32 s40, s2, 1
  s_mul_i32 s40, s40, 66560
  s_add_u32 s40, s40, 30932992
  s_and_b32 s41, s2, 1
  s_lshl_b32 s42, s41, 1
  s_add_u32 s42, s42, s20
  s_lshl_b32 s43, s42, 14
  s_add_u32 s43, s43, s40
  s_cmp_lt_u32 s2, 224
  s_cselect_b32 s43, s43, 0x40000000
  s_lshl_b32 s45, s42, 9
  s_add_u32 s45, s45, 38912
  s_lshl_b32 s44, s20, 8
  s_add_u32 s44, s44, 161792
  v_lshlrev_b32 v26, 3, v21
  v_add_u32 v26, s44, v26
  s_waitcnt vmcnt(33)
  s_barrier
  s_waitcnt vmcnt(29)
  s_barrier
  s_waitcnt vmcnt(0)
  s_mov_b64 exec, 1
  v_cmp_gt_u32 vcc, 256, v23
  s_mov_b64 exec, -1
  s_nop 3
  s_cbranch_vccz L_adaL_woL_pfok
  s_mov_b32 s62, 0
  s_mov_b64 exec, 1
L_adaL_woL_pf:
  v_mov_b32 v23, 0
  buffer_atomic_add v23, v22, s[8:11], s47 offen sc0 sc1
  s_add_u32 s62, s62, 1
  s_cmp_gt_u32 s62, 0x80000
  s_cbranch_scc1 L_adaL_woL_pfx
  s_waitcnt vmcnt(0)
  v_cmp_gt_u32 vcc, 256, v23
  s_nop 3
  s_cbranch_vccz L_adaL_woL_pfx
  s_sleep 2
  s_branch L_adaL_woL_pf
L_adaL_woL_pfx:
  s_mov_b64 exec, -1
L_adaL_woL_pfok:
  s_waitcnt vmcnt(25)
  s_barrier
  buffer_load_dwordx4 v[64:67], v24, s[8:11], s43 offen offset:0 sc1
  buffer_load_dwordx4 v[68:71], v24, s[8:11], s43 offen offset:256 sc1
  buffer_load_dwordx4 v[128:131], v25, s[8:11], s45 offen offset:0 sc1
  buffer_load_dwordx4 v[72:75], v24, s[8:11], s43 offen offset:2048 sc1
  buffer_load_dwordx4 v[76:79], v24, s[8:11], s43 offen offset:2304 sc1
  buffer_load_dwordx4 v[132:135], v25, s[8:11], s45 offen offset:64 sc1
  s_add_u32 s43, s43, 4096
  buffer_load_dwordx4 v[80:83], v24, s[8:11], s43 offen offset:0 sc1
  buffer_load_dwordx4 v[84:87], v24, s[8:11], s43 offen offset:256 sc1
  buffer_load_dwordx4 v[136:139], v25, s[8:11], s45 offen offset:128 sc1
  buffer_load_dwordx4 v[88:91], v24, s[8:11], s43 offen offset:2048 sc1
  buffer_load_dwordx4 v[92:95], v24, s[8:11], s43 offen offset:2304 sc1
  buffer_load_dwordx4 v[140:143], v25, s[8:11], s45 offen offset:192 sc1
  s_add_u32 s43, s43, 4096
  s_waitcnt vmcnt(33)
  s_barrier
  buffer_load_dwordx4 v[96:99], v24, s[8:11], s43 offen offset:0 sc1
  buffer_load_dwordx4 v[100:103], v24, s[8:11], s43 offen offset:256 sc1
  buffer_load_dwordx4 v[144:147], v25, s[8:11], s45 offen offset:256 sc1
  buffer_load_dwordx4 v[104:107], v24, s[8:11], s43 offen offset:2048 sc1
  buffer_load_dwordx4 v[108:111], v24, s[8:11], s43 offen offset:2304 sc1
  buffer_load_dwordx4 v[148:151], v25, s[8:11], s45 offen offset:320 sc1
  s_add_u32 s43, s43, 4096
  buffer_load_dwordx4 v[112:115], v24, s[8:11], s43 offen offset:0 sc1
  buffer_load_dwordx4 v[116:119], v24, s[8:11], s43 offen offset:256 sc1
  buffer_load_dwordx4 v[152:155], v25, s[8:11], s45 offen offset:384 sc1
  buffer_load_dwordx4 v[120:123], v24, s[8:11], s43 offen offset:2048 sc1
  buffer_load_dwordx4 v[124:127], v24, s[8:11], s43 offen offset:2304 sc1
  buffer_load_dwordx4 v[156:159], v25, s[8:11], s45 offen offset:448 sc1
  s_add_u32 s43, s43, 4096
  s_waitcnt vmcnt(41)
  s_barrier
  s_waitcnt vmcnt(37)
  s_barrier
  s_waitcnt vmcnt(33)
  s_barrier
  s_waitcnt vmcnt(29)
  s_barrier
  s_waitcnt vmcnt(0)
  v_mfma_f32_16x16x32_bf16 v[32:35], v[128:131], v[64:67], 0
  v_mfma_f32_16x16x32_bf16 v[36:39], v[128:131], v[68:71], 0
  v_mfma_f32_16x16x32_bf16 v[32:35], v[132:135], v[72:75], v[32:35]
  v_mfma_f32_16x16x32_bf16 v[36:39], v[132:135], v[76:79], v[36:39]
  v_mfma_f32_16x16x32_bf16 v[32:35], v[136:139], v[80:83], v[32:35]
  v_mfma_f32_16x16x32_bf16 v[36:39], v[136:139], v[84:87], v[36:39]
  v_mfma_f32_16x16x32_bf16 v[32:35], v[140:143], v[88:91], v[32:35]
  v_mfma_f32_16x16x32_bf16 v[36:39], v[140:143], v[92:95], v[36:39]
  v_mfma_f32_16x16x32_bf16 v[32:35], v[144:147], v[96:99], v[32:35]
  v_mfma_f32_16x16x32_bf16 v[36:39], v[144:147], v[100:103], v[36:39]
  v_mfma_f32_16x16x32_bf16 v[32:35], v[148:151], v[104:107], v[32:35]
  v_mfma_f32_16x16x32_bf16 v[36:39], v[148:151], v[108:111], v[36:39]
  v_mfma_f32_16x16x32_bf16 v[32:35], v[152:155], v[112:115], v[32:35]
  v_mfma_f32_16x16x32_bf16 v[36:39], v[152:155], v[116:119], v[36:39]
  v_mfma_f32_16x16x32_bf16 v[32:35], v[156:159], v[120:123], v[32:35]
  v_mfma_f32_16x16x32_bf16 v[36:39], v[156:159], v[124:127], v[36:39]
  s_nop 7
  ds_write_b64 v26, v[32:33]
  ds_write_b64 v26, v[36:37] offset:128
  s_waitcnt lgkmcnt(0)
  s_waitcnt vmcnt(25)
  s_barrier
  s_mov_b32 s57, 0
  s_cmp_lt_u32 s2, 224
  s_cselect_b32 s42, s3, 0
  s_cmp_lg_u32 s42, 3
  s_cbranch_scc1 L_adaL_woL_done
  v_and_b32 v26, 31, v0
  v_lshlrev_b32 v29, 4, v26
  v_lshlrev_b32 v26, 3, v26
  v_add_u32 v26, 161792, v26
  ds_read_b64 v[40:41], v26 offset:0
  ds_read_b64 v[42:43], v26 offset:256
  s_lshl_b32 s41, s41, 9
  s_add_u32 s40, s40, s41
  s_add_u32 s40, s40, 65536
  s_waitcnt lgkmcnt(0)
  v_add_f32 v40, v40, v42
  v_add_f32 v41, v41, v43
  v_cvt_pk_bf16_f32 v49, v40, v41
  v_lshlrev_b32 v42, 16, v49
  v_and_b32 v43, 0xffff0000, v49
  v_sub_f32 v42, v40, v42
  v_sub_f32 v43, v41, v43
  v_cvt_pk_bf16_f32 v48, v40, v42
  v_cvt_pk_bf16_f32 v50, v43, v41
  v_mov_b32 v51, 0
  buffer_store_dwordx4 v[48:51], v29, s[8:11], s40 offen sc1
  s_mul_i32 s56, s2, 4682
  s_lshr_b32 s56, s56, 16
  s_lshl_b32 s56, s56, 7
  s_add_u32 s56, s56, 395264
  s_mov_b32 s57, 9
L_adaL_woL_done:
  s_barrier
  s_and_b32 s16, s2, 7
  s_lshr_b32 s17, s2, 3
  s_and_b32 s18, s16, 1
  s_lshl_b32 s18, s18, 3
  s_and_b32 s19, s17, 7
  s_add_u32 s18, s18, s19
  s_lshr_b32 s19, s16, 1
  s_lshl_b32 s19, s19, 2
  s_lshr_b32 s17, s17, 3
  s_add_u32 s19, s19, s17
  s_mov_b32 s29, 0
  s_add_u32 s30, s29, 65536
  s_bfe_u32 s46, s19, 131074
  s_mul_i32 s28, s46, 16384
  s_max_u32 s28, s28, s29
  s_mov_b32 s31, 0
  s_and_b32 s20, s3, 1
  s_cmp_ge_u32 s3, 2
  s_cbranch_scc1 L_adaL_ffn1L_W
  v_mov_b32 v26, 163780
  s_mov_b32 s48, 0
  s_mov_b32 s49, 0
  v_lshlrev_b32 v56, 7, v0
  v_mov_b32 v57, 0
  s_lshl_b32 s50, s18, 9
  s_add_u32 s50, s50, 409600
  s_lshl_b32 s22, s18, 1
  s_add_u32 s22, s22, s20
  s_mul_i32 s22, s22, 133120
  s_add_u32 s22, s22, 22282240
  v_add_u32 v8, s22, v2
  v_add_u32 v9, 66560, v8
  s_mul_i32 s25, s20, 4096
  s_add_u32 s26, s25, 32768
  s_mov_b32 s27, s25
  s_mov_b32 s62, 0
  s_cmp_lg_u32 s3, 0
  s_cbranch_scc1 L_adaL_ffn1L_spin
L_adaL_ffn1L_dec:
  v_mov_b32 v57, 0
  s_mov_b64 exec, 15
  buffer_atomic_add v57, v56, s[8:11], s50 offen sc0 sc1
  s_mov_b64 exec, -1
  s_add_u32 s62, s62, 1
  s_waitcnt vmcnt(0)
  v_cmp_le_u32 vcc, 16, v57
  s_cmp_gt_u32 s62, 0x80000
  s_nop 2
  s_cselect_b32 s40, 15, vcc_lo
  s_and_b32 s40, s40, 15
  s_lshl_b32 s42, s40, 4
  s_or_b32 s40, s40, s42
  s_lshr_b32 s42, s40, s46
  s_ff0_i32_b32 s43, s42
  s_cmp_lt_u32 s43, 1
  s_cbranch_scc1 L_adaL_ffn1L_dec
  s_mul_i32 s48, s43, 8
  s_sub_u32 s49, s48, 1
  v_mov_b32 v57, 0
  v_mov_b32 v27, 1
  ds_write_b32 v26, v27
  s_branch L_adaL_ffn1L_have
L_adaL_ffn1L_spin:
  ds_read_b32 v27, v26
  s_add_u32 s62, s62, 1
  s_waitcnt lgkmcnt(0)
  v_readfirstlane_b32 s44, v27
  s_cmp_gt_u32 s62, 0x2000000
  s_cselect_b32 s44, 1, s44
  s_cmp_lg_u32 s44, 0
  s_cbranch_scc1 L_adaL_ffn1L_have
  s_sleep 1
  s_branch L_adaL_ffn1L_spin
L_adaL_ffn1L_have:
L_adaL_ffn1L_xloop:
  s_cmp_lt_u32 s31, 3
  s_cbranch_scc1 L_adaL_ffn1L_xskip
  s_waitcnt vmcnt(8)
  s_cmp_eq_u32 s31, s48
  s_cbranch_scc1 L_adaL_ffn1L_chkb
L_adaL_ffn1L_chkbr:
  s_barrier
L_adaL_ffn1L_xskip:
  s_add_u32 m0, s27, 0
  s_nop 0
  buffer_load_dwordx4 v8, s[8:11], s28 offen offset:0 sc1 lds
  buffer_load_dwordx4 v8, s[8:11], s28 offen offset:1024 sc1 lds
  s_add_u32 m0, s27, 2048
  s_nop 0
  buffer_load_dwordx4 v9, s[8:11], s28 offen offset:0 sc1 lds
  buffer_load_dwordx4 v9, s[8:11], s28 offen offset:1024 sc1 lds
  s_add_u32 s28, s28, 2048
  s_cmp_eq_u32 s28, s30
  s_cselect_b32 s28, s29, s28
  s_add_u32 s27, s27, 8192
  s_cmp_eq_u32 s27, s26
  s_cselect_b32 s27, s25, s27
  s_add_u32 s31, s31, 1
  s_cmp_eq_u32 s31, s49
  s_cbranch_scc1 L_adaL_ffn1L_chka
L_adaL_ffn1L_chkar:
  s_cmp_lt_u32 s31, 32
  s_cbranch_scc1 L_adaL_ffn1L_xloop
  s_waitcnt vmcnt(8)
  s_barrier
  s_waitcnt vmcnt(4)
  s_barrier
  s_waitcnt vmcnt(0)
  s_barrier
  s_barrier
  s_branch L_adaL_ffn1L_done
L_adaL_ffn1L_W:
  s_mul_i32 s21, s19, 465920
  s_add_u32 s21, s21, 30932992
  s_lshl_b32 s25, s20, 10
  s_add_u32 s22, s21, s25
  v_add_u32 v8, s22, v2
  v_add_u32 v9, 66560, v8
  v_add_u32 v10, 133120, v8
  v_add_u32 v11, 199680, v8
  v_add_u32 v12, 266240, v8
  v_add_u32 v13, 332800, v8
  v_add_u32 v14, 399360, v8
  s_add_u32 s25, s25, 32768
  s_add_u32 s26, s25, 129024
  s_add_u32 s27, s25, 0
L_adaL_ffn1L_wloop:
  s_cmp_lt_u32 s31, 8
  s_cbranch_scc1 L_adaL_ffn1L_wskip
  s_waitcnt vmcnt(49)
  s_barrier
L_adaL_ffn1L_wskip:
  s_add_u32 m0, s27, 0
  s_nop 0
  buffer_load_dwordx4 v8, s[8:11], s28 offen offset:0 sc1 lds
  s_add_u32 m0, s27, 2048
  s_nop 0
  buffer_load_dwordx4 v9, s[8:11], s28 offen offset:0 sc1 lds
  s_add_u32 m0, s27, 4096
  s_nop 0
  buffer_load_dwordx4 v10, s[8:11], s28 offen offset:0 sc1 lds
  s_add_u32 m0, s27, 6144
  s_nop 0
  buffer_load_dwordx4 v11, s[8:11], s28 offen offset:0 sc1 lds
  s_add_u32 m0, s27, 8192
  s_nop 0
  buffer_load_dwordx4 v12, s[8:11], s28 offen offset:0 sc1 lds
  s_add_u32 m0, s27, 10240
  s_nop 0
  buffer_load_dwordx4 v13, s[8:11], s28 offen offset:0 sc1 lds
  s_add_u32 m0, s27, 12288
  s_nop 0
  buffer_load_dwordx4 v14, s[8:11], s28 offen offset:0 sc1 lds
  s_add_u32 s28, s28, 2048
  s_cmp_eq_u32 s28, s30
  s_cselect_b32 s28, s29, s28
  s_add_u32 s27, s27, 14336
  s_cmp_eq_u32 s27, s26
  s_cselect_b32 s27, s25, s27
  s_add_u32 s31, s31, 1
  s_cmp_eq_u32 s31, s57
  s_cbranch_scc1 L_adaL_ffn1L_usig
L_adaL_ffn1L_usigr:
  s_cmp_lt_u32 s31, 32
  s_cbranch_scc1 L_adaL_ffn1L_wloop
  s_lshl_b32 s47, s19, 7
  s_add_u32 s47, s47, 395264
  s_lshl_b32 s41, s18, 9
  s_add_u32 s41, s41, 409664
  s_sub_u32 s41, s41, s47
  v_mul_lo_u32 v22, v0, s41
  v_mul_u32_u24 v24, 50, v0
  v_add_u32 v24, 14, v24
  v_mov_b32 v23, 0
  s_mov_b64 exec, 3
  buffer_atomic_add v23, v22, s[8:11], s47 offen sc0 sc1
  s_mov_b64 exec, -1
  v_lshlrev_b32 v21, 3, v0
  s_mul_i32 s44, s20, 266240
  s_add_u32 s44, s44, s21
  s_add_u32 s44, s44, 65536
  s_lshl_b32 s40, s20, 12
  s_add_u32 s45, s40, 104448
  v_lshrrev_b32 v34, 5, v0
  v_mul_u32_u24 v34, 1536, v34
  v_add_u32 v34, v34, v2
  s_add_u32 s40, s40, 0
  v_add_u32 v34, s40, v34
  s_lshl_b32 s42, s18, 1
  s_add_u32 s42, s42, s20
  s_lshl_b32 s43, s42, 14
  s_add_u32 s43, s43, 524288
  s_waitcnt vmcnt(50)
  s_barrier
  s_getpc_b64 s[60:61]
L_adaL_ffn1L_pc6620:
  s_add_u32 s60, s60, adaLN_cond__softmax_full_mha__dense_activation_relu__prompt_kernel-L_adaL_ffn1L_pc6620
  s_addc_u32 s61, s61, -1
  s_lshr_b32 s62, s2, 3
  s_lshl_b32 s62, s62, 11
  v_and_b32 v54, 15, v0
  v_lshlrev_b32 v54, 7, v54
  v_add_u32 v54, s62, v54
  v_min_u32 v54, adaLN_cond__softmax_full_mha__dense_activation_relu__prompt_kernel_end-adaLN_cond__softmax_full_mha__dense_activation_relu__prompt_kernel-4, v54
  v_mov_b32 v55, s61
  v_add_co_u32 v54, vcc, s60, v54
  s_nop 1
  v_addc_co_u32 v55, vcc, 0, v55, vcc
  global_load_dword v56, v[54:55], off
  s_waitcnt vmcnt(44)
  s_barrier
  s_waitcnt vmcnt(0)
  s_mov_b64 exec, 3
  v_cmp_gt_u32 vcc, v24, v23
  s_mov_b64 exec, -1
  s_nop 3
  s_cbranch_vccz L_adaL_ffn1L_puok
  s_mov_b32 s62, 0
  s_mov_b64 exec, 3
L_adaL_ffn1L_pu:
  v_mov_b32 v23, 0
  buffer_atomic_add v23, v22, s[8:11], s47 offen sc0 sc1
  s_add_u32 s62, s62, 1
  s_cmp_gt_u32 s62, 0x80000
  s_cbranch_scc1 L_adaL_ffn1L_pux
  s_waitcnt vmcnt(0)
  v_cmp_gt_u32 vcc, v24, v23
  s_nop 3
  s_cbranch_vccz L_adaL_ffn1L_pux
  s_sleep 2
  s_branch L_adaL_ffn1L_pu
L_adaL_ffn1L_pux:
  s_mov_b64 exec, -1
L_adaL_ffn1L_puok:
  buffer_load_dwordx2 v[64:65], v21, s[8:11], s43 offen offset:0 sc1
  buffer_load_dwordx2 v[66:67], v21, s[8:11], s43 offen offset:512 sc1
  buffer_load_dwordx2 v[68:69], v21, s[8:11], s43 offen offset:1024 sc1
  buffer_load_dwordx2 v[70:71], v21, s[8:11], s43 offen offset:1536 sc1
  buffer_load_dwordx2 v[72:73], v21, s[8:11], s43 offen offset:2048 sc1
  buffer_load_dwordx2 v[74:75], v21, s[8:11], s43 offen offset:2560 sc1
  buffer_load_dwordx2 v[76:77], v21, s[8:11], s43 offen offset:3072 sc1
  buffer_load_dwordx2 v[78:79], v21, s[8:11], s43 offen offset:3584 sc1
  s_add_u32 s43, s43, 4096
  buffer_load_dwordx2 v[80:81], v21, s[8:11], s43 offen offset:0 sc1
  buffer_load_dwordx2 v[82:83], v21, s[8:11], s43 offen offset:512 sc1
  buffer_load_dwordx2 v[84:85], v21, s[8:11], s43 offen offset:1024 sc1
  buffer_load_dwordx2 v[86:87], v21, s[8:11], s43 offen offset:1536 sc1
  buffer_load_dwordx2 v[88:89], v21, s[8:11], s43 offen offset:2048 sc1
  buffer_load_dwordx2 v[90:91], v21, s[8:11], s43 offen offset:2560 sc1
  buffer_load_dwordx2 v[92:93], v21, s[8:11], s43 offen offset:3072 sc1
  buffer_load_dwordx2 v[94:95], v21, s[8:11], s43 offen offset:3584 sc1
  s_add_u32 s43, s43, 4096
  s_waitcnt vmcnt(53)
  s_barrier
  buffer_load_dwordx2 v[96:97], v21, s[8:11], s43 offen offset:0 sc1
  buffer_load_dwordx2 v[98:99], v21, s[8:11], s43 offen offset:512 sc1
  buffer_load_dwordx2 v[100:101], v21, s[8:11], s43 offen offset:1024 sc1
  buffer_load_dwordx2 v[102:103], v21, s[8:11], s43 offen offset:1536 sc1
  buffer_load_dwordx2 v[104:105], v21, s[8:11], s43 offen offset:2048 sc1
  buffer_load_dwordx2 v[106:107], v21, s[8:11], s43 offen offset:2560 sc1
  buffer_load_dwordx2 v[108:109], v21, s[8:11], s43 offen offset:3072 sc1
  buffer_load_dwordx2 v[110:111], v21, s[8:11], s43 offen offset:3584 sc1
  s_add_u32 s43, s43, 4096
  buffer_load_dwordx2 v[112:113], v21, s[8:11], s43 offen offset:0 sc1
  buffer_load_dwordx2 v[114:115], v21, s[8:11], s43 offen offset:512 sc1
  buffer_load_dwordx2 v[116:117], v21, s[8:11], s43 offen offset:1024 sc1
  buffer_load_dwordx2 v[118:119], v21, s[8:11], s43 offen offset:1536 sc1
  buffer_load_dwordx2 v[120:121], v21, s[8:11], s43 offen offset:2048 sc1
  buffer_load_dwordx2 v[122:123], v21, s[8:11], s43 offen offset:2560 sc1
  buffer_load_dwordx2 v[124:125], v21, s[8:11], s43 offen offset:3072 sc1
  buffer_load_dwordx2 v[126:127], v21, s[8:11], s43 offen offset:3584 sc1
  s_add_u32 s43, s43, 4096
  s_waitcnt vmcnt(62)
  s_barrier
  s_add_u32 m0, s45, 0
  s_nop 0
  buffer_load_dwordx4 v2, s[8:11], s44 offen sc1 lds
  s_add_u32 s44, s44, 66560
  s_add_u32 m0, s45, 1024
  s_nop 0
  buffer_load_dwordx4 v2, s[8:11], s44 offen sc1 lds
  s_add_u32 s44, s44, 66560
  s_add_u32 m0, s45, 2048
  s_nop 0
  buffer_load_dwordx4 v2, s[8:11], s44 offen sc1 lds
  s_add_u32 s44, s44, 66560
  s_add_u32 m0, s45, 3072
  s_nop 0
  buffer_load_dwordx4 v2, s[8:11], s44 offen sc1 lds
  s_add_u32 s44, s44, 66560
  s_waitcnt vmcnt(59)
  s_barrier
  s_waitcnt vmcnt(52)
  s_barrier
  s_waitcnt vmcnt(4)
  v_add_f32 v64, v64, v96
  v_add_f32 v65, v65, v97
  v_add_f32 v66, v66, v98
  v_add_f32 v67, v67, v99
  v_add_f32 v68, v68, v100
  v_add_f32 v69, v69, v101
  v_add_f32 v70, v70, v102
  v_add_f32 v71, v71, v103
  v_add_f32 v72, v72, v104
  v_add_f32 v73, v73, v105
  v_add_f32 v74, v74, v106
  v_add_f32 v75, v75, v107
  v_add_f32 v76, v76, v108
  v_add_f32 v77, v77, v109
  v_add_f32 v78, v78, v110
  v_add_f32 v79, v79, v111
  v_add_f32 v80, v80, v112
  v_add_f32 v81, v81, v113
  v_add_f32 v82, v82, v114
  v_add_f32 v83, v83, v115
  v_add_f32 v84, v84, v116
  v_add_f32 v85, v85, v117
  v_add_f32 v86, v86, v118
  v_add_f32 v87, v87, v119
  v_add_f32 v88, v88, v120
  v_add_f32 v89, v89, v121
  v_add_f32 v90, v90, v122
  v_add_f32 v91, v91, v123
  v_add_f32 v92, v92, v124
  v_add_f32 v93, v93, v125
  v_add_f32 v94, v94, v126
  v_add_f32 v95, v95, v127
  v_add_f32 v64, v64, v80
  v_add_f32 v65, v65, v81
  v_add_f32 v66, v66, v82
  v_add_f32 v67, v67, v83
  v_add_f32 v68, v68, v84
  v_add_f32 v69, v69, v85
  v_add_f32 v70, v70, v86
  v_add_f32 v71, v71, v87
  v_add_f32 v72, v72, v88
  v_add_f32 v73, v73, v89
  v_add_f32 v74, v74, v90
  v_add_f32 v75, v75, v91
  v_add_f32 v76, v76, v92
  v_add_f32 v77, v77, v93
  v_add_f32 v78, v78, v94
  v_add_f32 v79, v79, v95
  v_add_f32 v64, v64, v72
  v_add_f32 v65, v65, v73
  v_add_f32 v66, v66, v74
  v_add_f32 v67, v67, v75
  v_add_f32 v68, v68, v76
  v_add_f32 v69, v69, v77
  v_add_f32 v70, v70, v78
  v_add_f32 v71, v71, v79
  v_add_f32 v64, v64, v68
  v_add_f32 v65, v65, v69
  v_add_f32 v66, v66, v70
  v_add_f32 v67, v67, v71
  v_add_f32 v64, v64, v66
  v_add_f32 v65, v65, v67
  s_waitcnt vmcnt(45)
  s_barrier
  v_mul_f32 v28, 0xba800000, v64
  v_mul_f32 v29, 0x3a800000, v65
  v_fma_f32 v29, -v28, v28, v29
  v_max_f32 v29, 0, v29
  v_add_f32 v29, 0x3727c5ac, v29
  v_sqrt_f32 v29, v29
  s_nop 0
  v_rcp_f32 v30, v29
  v_cvt_pk_bf16_f32 v31, v28, v29
  v_lshlrev_b32 v32, 16, v31
  v_and_b32 v33, 0xffff0000, v31
  v_sub_f32 v32, v28, v32
  v_sub_f32 v33, v29, v33
  v_cvt_pk_bf16_f32 v36, v28, v28
  v_cvt_pk_bf16_f32 v37, v32, v29
  v_cvt_pk_bf16_f32 v38, v29, v33
  v_mov_b32 v39, 0
  v_mov_b32 v40, 0
  v_mov_b32 v41, 0
  v_mov_b32 v42, 0
  v_mov_b32 v43, 0
  ds_write_b128 v34, v[36:39]
  ds_write_b128 v34, v[36:39] offset:512
  ds_write_b128 v34, v[40:43] offset:1024
  ds_write_b128 v34, v[40:43] offset:1536
  s_waitcnt vmcnt(38)
  s_barrier
  s_waitcnt vmcnt(0) lgkmcnt(0)
  s_barrier
L_adaL_ffn1L_done:
  s_barrier
  s_and_b32 s16, s2, 7
  s_lshr_b32 s17, s2, 3
  s_and_b32 s18, s16, 1
  s_lshl_b32 s18, s18, 3
  s_and_b32 s19, s17, 7
  s_add_u32 s18, s18, s19
  s_lshr_b32 s19, s16, 1
  s_lshl_b32 s19, s19, 2
  s_lshr_b32 s17, s17, 3
  s_add_u32 s19, s19, s17
  s_lshr_b32 s17, s19, 3
  s_and_b32 s19, s19, 7
  s_mul_i32 s29, s17, 131072
  s_add_u32 s30, s29, 98304
  s_bfe_u32 s46, s19, 65538
  s_lshl_b32 s28, s17, 1
  s_add_u32 s46, s46, s28
  s_mul_i32 s28, s46, 57344
  s_max_u32 s28, s28, s29
  s_mov_b32 s31, 0
  s_and_b32 s20, s3, 1
  s_cmp_ge_u32 s3, 2
  s_cbranch_scc1 L_adaL_ffn2L_W
  v_mov_b32 v26, 163784
  s_mov_b32 s48, 0
  s_mov_b32 s49, 0
  v_lshlrev_b32 v56, 7, v0
  v_mov_b32 v57, 0
  s_lshl_b32 s50, s18, 9
  s_add_u32 s50, s50, 417792
  s_lshl_b32 s22, s18, 1
  s_add_u32 s22, s22, s20
  s_mul_i32 s22, s22, 460800
  s_add_u32 s22, s22, 48234496
  v_add_u32 v8, s22, v2
  v_add_u32 v9, 230400, v8
  s_mul_i32 s25, s20, 8192
  s_add_u32 s26, s25, 65536
  s_mov_b32 s27, s25
  s_mov_b32 s62, 0
  s_cmp_lg_u32 s3, 0
  s_cbranch_scc1 L_adaL_ffn2L_spin
L_adaL_ffn2L_dec:
  v_mov_b32 v57, 0
  s_mov_b64 exec, 15
  buffer_atomic_add v57, v56, s[8:11], s50 offen sc0 sc1
  s_mov_b64 exec, -1
  s_add_u32 s62, s62, 1
  s_waitcnt vmcnt(0)
  v_cmp_le_u32 vcc, 16, v57
  s_cmp_gt_u32 s62, 0x80000
  s_nop 2
  s_cselect_b32 s40, 15, vcc_lo
  s_and_b32 s40, s40, 15
  s_lshl_b32 s42, s40, 4
  s_or_b32 s40, s40, s42
  s_lshr_b32 s42, s40, s46
  s_ff0_i32_b32 s43, s42
  s_cmp_lt_u32 s43, 1
  s_cbranch_scc1 L_adaL_ffn2L_dec
  s_cmp_lt_u32 s43, 4
  s_cselect_b32 s48, 10, 99
  s_sub_u32 s49, s48, 1
  v_mov_b32 v57, 0
  v_mov_b32 v27, 1
  ds_write_b32 v26, v27
  s_branch L_adaL_ffn2L_have
L_adaL_ffn2L_spin:
  ds_read_b32 v27, v26
  s_add_u32 s62, s62, 1
  s_waitcnt lgkmcnt(0)
  v_readfirstlane_b32 s44, v27
  s_cmp_gt_u32 s62, 0x2000000
  s_cselect_b32 s44, 1, s44
  s_cmp_lg_u32 s44, 0
  s_cbranch_scc1 L_adaL_ffn2L_have
  s_sleep 1
  s_branch L_adaL_ffn2L_spin
L_adaL_ffn2L_have:
L_adaL_ffn2L_xloop:
  s_cmp_lt_u32 s31, 3
  s_cbranch_scc1 L_adaL_ffn2L_xskip
  s_waitcnt vmcnt(16)
  s_cmp_eq_u32 s31, s48
  s_cbranch_scc1 L_adaL_ffn2L_chkb
L_adaL_ffn2L_chkbr:
  s_barrier
L_adaL_ffn2L_xskip:
  s_add_u32 m0, s27, 0
  s_nop 0
  buffer_load_dwordx4 v8, s[8:11], s28 offen offset:0 sc1 lds
  buffer_load_dwordx4 v8, s[8:11], s28 offen offset:1024 sc1 lds
  buffer_load_dwordx4 v8, s[8:11], s28 offen offset:2048 sc1 lds
  buffer_load_dwordx4 v8, s[8:11], s28 offen offset:3072 sc1 lds
  s_add_u32 m0, s27, 4096
  s_nop 0
  buffer_load_dwordx4 v9, s[8:11], s28 offen offset:0 sc1 lds
  buffer_load_dwordx4 v9, s[8:11], s28 offen offset:1024 sc1 lds
  buffer_load_dwordx4 v9, s[8:11], s28 offen offset:2048 sc1 lds
  buffer_load_dwordx4 v9, s[8:11], s28 offen offset:3072 sc1 lds
  s_add_u32 s28, s28, 4096
  s_cmp_eq_u32 s28, s30
  s_cselect_b32 s28, s29, s28
  s_add_u32 s27, s27, 16384
  s_cmp_eq_u32 s27, s26
  s_cselect_b32 s27, s25, s27
  s_add_u32 s31, s31, 1
  s_cmp_eq_u32 s31, 24
  s_cselect_b32 s28, 98304, s28
  s_cmp_eq_u32 s31, s49
  s_cbranch_scc1 L_adaL_ffn2L_chka
L_adaL_ffn2L_chkar:
  s_cmp_lt_u32 s31, 32
  s_cbranch_scc1 L_adaL_ffn2L_xloop
  s_waitcnt vmcnt(16)
  s_barrier
  s_waitcnt vmcnt(8)
  s_barrier
  s_waitcnt vmcnt(0)
  s_barrier
  s_branch L_adaL_ffn2L_done
L_adaL_ffn2L_W:
  s_lshl_b32 s23, s17, 3
  s_add_u32 s23, s23, s19
  s_lshl_b32 s23, s23, 1
  s_add_u32 s23, s23, s20
  s_mul_i32 s24, s23, 230400
  s_add_u32 s24, s24, 40763392
  v_add_u32 v8, s24, v2
  s_xor_b32 s23, s23, 16
  s_mul_i32 s24, s23, 230400
  s_add_u32 s24, s24, 40763392
  v_add_u32 v9, s24, v2
  s_mul_i32 s25, s20, 8192
  s_add_u32 s25, s25, 65536
  s_add_u32 s26, s25, 98304
  s_add_u32 s27, s25, 0
L_adaL_ffn2L_wloop:
  s_cmp_lt_u32 s31, 5
  s_cbranch_scc1 L_adaL_ffn2L_wskip
  s_waitcnt vmcnt(32)
  s_barrier
L_adaL_ffn2L_wskip:
  s_add_u32 m0, s27, 0
  s_nop 0
  buffer_load_dwordx4 v8, s[8:11], s28 offen offset:0 sc1 lds
  buffer_load_dwordx4 v8, s[8:11], s28 offen offset:1024 sc1 lds
  buffer_load_dwordx4 v8, s[8:11], s28 offen offset:2048 sc1 lds
  buffer_load_dwordx4 v8, s[8:11], s28 offen offset:3072 sc1 lds
  s_add_u32 m0, s27, 4096
  s_nop 0
  buffer_load_dwordx4 v9, s[8:11], s28 offen offset:0 sc1 lds
  buffer_load_dwordx4 v9, s[8:11], s28 offen offset:1024 sc1 lds
  buffer_load_dwordx4 v9, s[8:11], s28 offen offset:2048 sc1 lds
  buffer_load_dwordx4 v9, s[8:11], s28 offen offset:3072 sc1 lds
  s_add_u32 s28, s28, 4096
  s_cmp_eq_u32 s28, s30
  s_cselect_b32 s28, s29, s28
  s_add_u32 s27, s27, 16384
  s_cmp_eq_u32 s27, s26
  s_cselect_b32 s27, s25, s27
  s_add_u32 s31, s31, 1
  s_cmp_eq_u32 s31, 24
  s_cselect_b32 s28, 98304, s28
  s_cmp_lt_u32 s31, 24
  s_cbranch_scc1 L_adaL_ffn2L_wloop
L_adaL_ffn2L_zloop:
  s_waitcnt vmcnt(16)
  s_barrier
  s_add_u32 m0, s27, 0
  s_nop 0
  buffer_load_dwordx4 v8, s[8:11], s28 offen offset:0 sc1 lds
  buffer_load_dwordx4 v8, s[8:11], s28 offen offset:1024 sc1 lds
  buffer_load_dwordx4 v8, s[8:11], s28 offen offset:2048 sc1 lds
  buffer_load_dwordx4 v8, s[8:11], s28 offen offset:3072 sc1 lds
  s_add_u32 s28, s28, 4096
  s_cmp_eq_u32 s28, s30
  s_cselect_b32 s28, s29, s28
  s_add_u32 s27, s27, 16384
  s_cmp_eq_u32 s27, s26
  s_cselect_b32 s27, s25, s27
  s_add_u32 s31, s31, 1
  s_cmp_eq_u32 s31, 24
  s_cselect_b32 s28, 98304, s28
  s_cmp_lt_u32 s31, 32
  s_cbranch_scc1 L_adaL_ffn2L_zloop
  s_waitcnt vmcnt(16)
  s_barrier
  s_lshl_b32 s40, s20, 8
  s_add_u32 s40, s40, 98304
  v_lshlrev_b32 v21, 2, v0
  v_add_u32 v21, s40, v21
  ds_write_b32 v21, v30
  s_waitcnt lgkmcnt(0)
  s_getpc_b64 s[60:61]
L_adaL_ffn2L_pc7013:
  s_add_u32 s60, s60, adaLN_cond__softmax_full_mha__dense_activation_relu__prompt_kernel-L_adaL_ffn2L_pc7013
  s_addc_u32 s61, s61, -1
  s_lshr_b32 s62, s2, 3
  s_lshl_b32 s62, s62, 11
  v_and_b32 v54, 15, v0
  v_lshlrev_b32 v54, 7, v54
  v_add_u32 v54, s62, v54
  v_min_u32 v54, adaLN_cond__softmax_full_mha__dense_activation_relu__prompt_kernel_end-adaLN_cond__softmax_full_mha__dense_activation_relu__prompt_kernel-4, v54
  v_mov_b32 v55, s61
  v_add_co_u32 v54, vcc, s60, v54
  s_nop 1
  v_addc_co_u32 v55, vcc, 0, v55, vcc
  global_load_dword v56, v[54:55], off
  s_waitcnt vmcnt(13)
  s_barrier
  s_waitcnt vmcnt(9)
  s_barrier
  s_waitcnt vmcnt(5)
  s_barrier
  s_waitcnt vmcnt(1)
  s_barrier
L_adaL_ffn2L_done:
  s_endpgm
L_adaL_qkvL_early0:
  s_cmp_lg_u32 s31, 7
  s_cbranch_scc1 L_adaL_qkvL_e0_1
  s_waitcnt vmcnt(12)
  s_branch L_adaL_qkvL_lbar0
L_adaL_qkvL_e0_1:
  s_cmp_lg_u32 s31, 8
  s_cbranch_scc1 L_adaL_qkvL_e0_2
  s_waitcnt vmcnt(15)
  s_branch L_adaL_qkvL_lbar0
L_adaL_qkvL_e0_2:
  s_cmp_lg_u32 s31, 9
  s_cbranch_scc1 L_adaL_qkvL_e0_3
  s_waitcnt vmcnt(18)
  s_branch L_adaL_qkvL_lbar0
L_adaL_qkvL_e0_3:
  s_cmp_lg_u32 s31, 10
  s_cbranch_scc1 L_adaL_qkvL_e0_4
  s_waitcnt vmcnt(21)
  s_branch L_adaL_qkvL_lbar0
L_adaL_qkvL_e0_4:
  s_cmp_lg_u32 s31, 11
  s_cbranch_scc1 L_adaL_qkvL_e0_5
  s_waitcnt vmcnt(24)
  s_branch L_adaL_qkvL_lbar0
L_adaL_qkvL_e0_5:
  s_waitcnt vmcnt(27)
  s_branch L_adaL_qkvL_lbar0
L_adaL_woL_chka:
  s_mov_b64 exec, 15
  buffer_atomic_add v57, v56, s[8:11], s50 offen sc0 sc1
  s_mov_b64 exec, -1
  s_branch L_adaL_woL_chkar
L_adaL_woL_chkb:
  s_waitcnt vmcnt(8)
  s_mov_b64 exec, 15
  v_cmp_gt_u32 vcc, 16, v57
  s_mov_b64 exec, -1
  s_nop 3
  s_cbranch_vccz L_adaL_woL_chkbr
  v_lshlrev_b32 v56, 7, v0
  s_mov_b32 s62, 0
  s_mov_b64 exec, 15
L_adaL_woL_pb:
  v_mov_b32 v57, 0
  buffer_atomic_add v57, v56, s[8:11], s50 offen sc0 sc1
  s_add_u32 s62, s62, 1
  s_cmp_gt_u32 s62, 0x80000
  s_cbranch_scc1 L_adaL_woL_pbx
  s_waitcnt vmcnt(0)
  v_cmp_gt_u32 vcc, 16, v57
  s_nop 3
  s_cbranch_vccz L_adaL_woL_pbx
  s_sleep 2
  s_branch L_adaL_woL_pb
L_adaL_woL_pbx:
  s_mov_b64 exec, -1
  s_branch L_adaL_woL_chkbr
L_adaL_ffn1L_chka:
  s_mov_b64 exec, 15
  buffer_atomic_add v57, v56, s[8:11], s50 offen sc0 sc1
  s_mov_b64 exec, -1
  s_branch L_adaL_ffn1L_chkar
L_adaL_ffn1L_chkb:
  s_waitcnt vmcnt(4)
  s_mov_b64 exec, 15
  v_cmp_gt_u32 vcc, 16, v57
  s_mov_b64 exec, -1
  s_nop 3
  s_cbranch_vccz L_adaL_ffn1L_chkbr
  v_lshlrev_b32 v56, 7, v0
  s_mov_b32 s62, 0
  s_mov_b64 exec, 15
L_adaL_ffn1L_pb:
  v_mov_b32 v57, 0
  buffer_atomic_add v57, v56, s[8:11], s50 offen sc0 sc1
  s_add_u32 s62, s62, 1
  s_cmp_gt_u32 s62, 0x80000
  s_cbranch_scc1 L_adaL_ffn1L_pbx
  s_waitcnt vmcnt(0)
  v_cmp_gt_u32 vcc, 16, v57
  s_nop 3
  s_cbranch_vccz L_adaL_ffn1L_pbx
  s_sleep 2
  s_branch L_adaL_ffn1L_pb
L_adaL_ffn1L_pbx:
  s_mov_b64 exec, -1
  s_branch L_adaL_ffn1L_chkbr
L_adaL_ffn1L_usig:
  v_mov_b32 v58, 0
  v_mov_b32 v59, 1
  s_mov_b64 exec, 1
  buffer_atomic_add v59, v58, s[8:11], s56 offen sc1
  s_mov_b64 exec, -1
  s_branch L_adaL_ffn1L_usigr
L_adaL_ffn2L_chka:
  s_mov_b64 exec, 15
  buffer_atomic_add v57, v56, s[8:11], s50 offen sc0 sc1
  s_mov_b64 exec, -1
  s_branch L_adaL_ffn2L_chkar
L_adaL_ffn2L_chkb:
  s_waitcnt vmcnt(8)
  s_mov_b64 exec, 15
  v_cmp_gt_u32 vcc, 16, v57
  s_mov_b64 exec, -1
  s_nop 3
  s_cbranch_vccz L_adaL_ffn2L_chkbr
  v_lshlrev_b32 v56, 7, v0
  s_mov_b32 s62, 0
  s_mov_b64 exec, 15
L_adaL_ffn2L_pb:
  v_mov_b32 v57, 0
  buffer_atomic_add v57, v56, s[8:11], s50 offen sc0 sc1
  s_add_u32 s62, s62, 1
  s_cmp_gt_u32 s62, 0x80000
  s_cbranch_scc1 L_adaL_ffn2L_pbx
  s_waitcnt vmcnt(0)
  v_cmp_gt_u32 vcc, 16, v57
  s_nop 3
  s_cbranch_vccz L_adaL_ffn2L_pbx
  s_sleep 2
  s_branch L_adaL_ffn2L_pb
L_adaL_ffn2L_pbx:
  s_mov_b64 exec, -1
  s_branch L_adaL_ffn2L_chkbr
L_adaL_end:
  s_endpgm
adaLN_cond__softmax_full_mha__dense_activation_relu__prompt_kernel_end:
.section .rodata,"a"
.p2align 6
.amdhsa_kernel adaLN_cond__softmax_full_mha__dense_activation_relu__prompt_kernel
  .amdhsa_next_free_vgpr 256
  .amdhsa_next_free_sgpr 96
  .amdhsa_accum_offset 256
  .amdhsa_group_segment_fixed_size 0
  .amdhsa_kernarg_size 88
  .amdhsa_user_sgpr_count 2
  .amdhsa_user_sgpr_kernarg_segment_ptr 1
  .amdhsa_system_sgpr_workgroup_id_x 1
  .amdhsa_float_denorm_mode_32 3
.end_amdhsa_kernel
```
